```python
import torch

def _softmax(x, axis=-1):
    return torch.softmax(x, dim=axis)
def _gelu(x):
    return torch.nn.functional.gelu(x, approximate="tanh")
def _silu(x):
    return torch.nn.functional.silu(x)
def _sigmoid(x):
    return torch.sigmoid(x)
def _layernorm(x, axis=-1, eps=1e-5):
    m = x.mean(dim=axis, keepdim=True)
    v = x.var(dim=axis, keepdim=True, unbiased=False)
    return (x - m) / torch.sqrt(v + eps)
def _scatter_add(tgt, idx, src, axis=0):
    return tgt.clone().index_add_(axis, idx, src)
def _segment_sum(src, seg, n):
    out = torch.zeros((n,) + src.shape[1:], dtype=src.dtype)
    return out.index_add_(0, seg, src)
def _pad(x, pw):
    flat = tuple(v for pair in reversed(pw) for v in pair)
    return torch.nn.functional.pad(x, flat)

kernel_name = 'parallel_sum__gqa_block_cached__glu_gated_glu__decode'

def setup_inputs():

    _w = (lambda a: (lambda t: t.to(torch.bfloat16) if t.is_floating_point() else t)(torch.as_tensor(a)))
    def _A_setup():
        B, Sq, D = 1, 1, 576
        Hq, Hkv, Sk, Dh = 32, 16, 65536, 128
        assert Hq % Hkv == 0, (Hq, Hkv)
        return {
            "x": _w((lambda *s: torch.randn(*s, dtype=torch.bfloat16) * 0.05)(B, Sq, D)),
            "k_cache": _w((lambda *s: torch.randn(*s, dtype=torch.bfloat16) * 3.2)(B, Hkv, Sk, Dh)),
            "v_cache": _w((lambda *s: torch.randn(*s, dtype=torch.bfloat16) * 1.6)(B, Hkv, Sk, Dh)),
            "wq": _w((lambda *s: torch.randn(*s, dtype=torch.bfloat16) * 3.2)(D, Hq * Dh) * (D ** -0.5)),
            "wo": _w((lambda *s: torch.randn(*s, dtype=torch.bfloat16) * 1.6)(Hq * Dh, D) * ((Hq * Dh) ** -0.5)),
        }
    _A_in = _A_setup()

    def _B_setup():
        B, S, D, F = 1, 1, 576, 4608
        return {
            "x": _w((lambda *s: torch.randn(*s, dtype=torch.bfloat16) * 0.05)(B, S, D)),
            "w_gate": _w((lambda *s: torch.randn(*s, dtype=torch.bfloat16) * 0.1)(D, F)),
            "w_up": _w((lambda *s: torch.randn(*s, dtype=torch.bfloat16) * 0.05)(D, F)),
            "w_down": _w((lambda *s: torch.randn(*s, dtype=torch.bfloat16) * 0.05)(F, D)),
        }
    _B_in = _B_setup()

    return {
        "A_x": _A_in["x"],
        "A_k_cache": _A_in["k_cache"],
        "A_v_cache": _A_in["v_cache"],
        "A_wq": _A_in["wq"],
        "A_wo": _A_in["wo"],
        "B_x": _B_in["x"],
        "B_w_gate": _B_in["w_gate"],
        "B_w_up": _B_in["w_up"],
        "B_w_down": _B_in["w_down"],
    }

def reference(A_x, A_k_cache, A_v_cache, A_wq, A_wo, B_x, B_w_gate, B_w_up, B_w_down):
    def _A_ref(x, k_cache, v_cache, wq, wo):
        B, Sq, D = x.shape
        Hq, Dh = 32, 128
        Hkv = k_cache.shape[1]
        rep = Hq // Hkv
        q = (lambda x, *d: x.permute(*d))((x @ wq).reshape(B, Sq, Hq, Dh), 0, 2, 1, 3)
        k = (lambda x, n, axis: torch.repeat_interleave(x, n, dim=axis))(k_cache, rep, axis=1)
        v = (lambda x, n, axis: torch.repeat_interleave(x, n, dim=axis))(v_cache, rep, axis=1)
        scores = torch.einsum("bhqd,bhkd->bhqk", q, k) * (Dh ** -0.5)
        p = _softmax(scores, axis=-1)
        o = torch.einsum("bhqk,bhkd->bhqd", p, v)
        return (lambda x, *d: x.permute(*d))(o, 0, 2, 1, 3).reshape(B, Sq, Hq * Dh) @ wo

    def _B_ref(x, w_gate, w_up, w_down):
        g = torch.einsum("bsd,df->bsf", x, w_gate)
        u = torch.einsum("bsd,df->bsf", x, w_up)
        h = _sigmoid(g) * u
        return torch.einsum("bsf,fd->bsd", h, w_down)

    x = A_x
    xn = _layernorm(x, axis=-1)
    return x + _A_ref(xn, A_k_cache, A_v_cache, A_wq, A_wo) + _B_ref(xn, B_w_gate, B_w_up, B_w_down)
```

```asm
; @launch grid=(256,1,1) block=(512,1,1) lds=155440
.amdgcn_target "amdgcn-amd-amdhsa--gfx950"
.text
.globl parallel_sum__gqa_block_cached__glu_gated_glu__decode_kernel
.p2align 8
.type parallel_sum__gqa_block_cached__glu_gated_glu__decode_kernel,@function
parallel_sum__gqa_block_cached__glu_gated_glu__decode_kernel:
  s_cmp_ge_u32 s2, 256
  s_cbranch_scc1 L_end
  s_load_dwordx16 s[4:19], s[0:1], 0
  s_load_dwordx8 s[20:27], s[0:1], 64
  v_lshrrev_b32 v1, 6, v0
  v_and_b32 v0, 63, v0
  v_readfirstlane_b32 s3, v1
  s_mov_b32 s96, s2
  s_lshr_b32 s52, s2, 4
  s_and_b32 s53, s2, 15
  v_lshlrev_b32 v7, 4, v0
  v_lshlrev_b32 v6, 2, v0
  s_mov_b32 s38, 1152
  s_mov_b32 s39, 0x20000
  s_mov_b32 s43, 0x20000
  v_mov_b32 v1, 155392
  v_mov_b32 v32, 0
  v_mov_b32 v33, 0
  v_mov_b32 v34, 0
  v_mov_b32 v35, 0
  s_cmp_eq_u32 s3, 7
  s_cbranch_scc0 L_noinit
  ds_write_b128 v1, v[32:35]
  ds_write_b128 v1, v[32:35] offset:16
  ds_write_b128 v1, v[32:35] offset:32
  s_waitcnt lgkmcnt(0)
L_noinit:
  s_barrier
  s_cmp_ge_u32 s3, 4
  s_cbranch_scc1 L_stream
  s_cmp_eq_u32 s3, 0
  s_cbranch_scc0 L_notw0
  s_setprio 3
  v_lshrrev_b32 v1, 3, v0
  v_and_b32 v2, 7, v0
  s_lshr_b32 s56, s53, 2
  s_mul_i32 s56, s56, 144
  v_mad_u32_u24 v1, v1, 18, s56
  v_lshlrev_b32 v3, 13, v1
  v_lshl_add_u32 v3, v2, 4, v3
  v_lshlrev_b32 v1, 1, v1
  s_and_b32 s56, s53, 3
  s_lshl_b32 s56, s56, 7
  s_lshl_b32 s57, s52, 9
  s_add_u32 s56, s56, s57
  s_mov_b32 s42, 4718592
  s_waitcnt lgkmcnt(0)
  s_mov_b32 s36, s4
  s_mov_b32 s37, s5
  s_mov_b32 s40, s10
  s_mov_b32 s41, s11
  s_load_dword s48, s[26:27], 0
  buffer_load_dwordx4 v[52:55], v7, s[36:39], 0 offen
  buffer_load_dword v51, v6, s[36:39], 0 offen offset:1024
  buffer_load_dwordx4 v[64:67], v1, s[36:39], 0 offen
  buffer_load_dwordx4 v[68:71], v1, s[36:39], 0 offen offset:16
  buffer_load_dword v72, v1, s[36:39], 0 offen offset:32
  buffer_load_dwordx4 v[100:103], v3, s[40:43], s56 offen nt
  s_add_u32 s56, s56, 8192
  buffer_load_dwordx4 v[104:107], v3, s[40:43], s56 offen nt
  s_add_u32 s56, s56, 8192
  buffer_load_dwordx4 v[108:111], v3, s[40:43], s56 offen nt
  s_add_u32 s56, s56, 8192
  buffer_load_dwordx4 v[112:115], v3, s[40:43], s56 offen nt
  s_add_u32 s56, s56, 8192
  buffer_load_dwordx4 v[116:119], v3, s[40:43], s56 offen nt
  s_add_u32 s56, s56, 8192
  buffer_load_dwordx4 v[120:123], v3, s[40:43], s56 offen nt
  s_add_u32 s56, s56, 8192
  buffer_load_dwordx4 v[124:127], v3, s[40:43], s56 offen nt
  s_add_u32 s56, s56, 8192
  buffer_load_dwordx4 v[128:131], v3, s[40:43], s56 offen nt
  s_add_u32 s56, s56, 8192
  buffer_load_dwordx4 v[132:135], v3, s[40:43], s56 offen nt
  s_add_u32 s56, s56, 8192
  buffer_load_dwordx4 v[136:139], v3, s[40:43], s56 offen nt
  s_add_u32 s56, s56, 8192
  buffer_load_dwordx4 v[140:143], v3, s[40:43], s56 offen nt
  s_add_u32 s56, s56, 8192
  buffer_load_dwordx4 v[144:147], v3, s[40:43], s56 offen nt
  s_add_u32 s56, s56, 8192
  buffer_load_dwordx4 v[148:151], v3, s[40:43], s56 offen nt
  s_add_u32 s56, s56, 8192
  buffer_load_dwordx4 v[152:155], v3, s[40:43], s56 offen nt
  s_add_u32 s56, s56, 8192
  buffer_load_dwordx4 v[156:159], v3, s[40:43], s56 offen nt
  s_add_u32 s56, s56, 8192
  buffer_load_dwordx4 v[160:163], v3, s[40:43], s56 offen nt
  s_add_u32 s56, s56, 8192
  buffer_load_dwordx4 v[164:167], v3, s[40:43], s56 offen nt
  s_add_u32 s56, s56, 8192
  buffer_load_dwordx4 v[168:171], v3, s[40:43], s56 offen nt
  s_lshl_b32 s59, s2, 13
  s_lshl_b32 s60, s52, 17
  s_mov_b32 s62, 0
  s_mov_b32 s63, -1
  s_mov_b32 s64, 0x3fb8aa3b
  s_mov_b32 s65, 0x3db504f3
  s_add_u32 s44, s26, 65536
  s_addc_u32 s45, s27, 0
  s_mov_b32 s46, 2097152
  s_mov_b32 s47, 0x20000
  v_and_b32 v47, 1, v0
  v_lshlrev_b32 v47, 4, v47
  v_mov_b32 v48, 0xffff
  v_lshlrev_b32 v47, v47, v48
  v_bfe_u32 v48, v0, 1, 2
  v_cmp_eq_u32 vcc, 0, v48
  s_nop 1
  v_cndmask_b32 v8, 0, v47, vcc
  v_cmp_eq_u32 vcc, 1, v48
  s_nop 1
  v_cndmask_b32 v9, 0, v47, vcc
  v_cmp_eq_u32 vcc, 2, v48
  s_nop 1
  v_cndmask_b32 v10, 0, v47, vcc
  v_cmp_eq_u32 vcc, 3, v48
  s_nop 1
  v_cndmask_b32 v11, 0, v47, vcc
  v_mov_b32 v50, 0xff
  v_bfe_u32 v3, v0, 4, 1
  v_lshlrev_b32 v3, 5, v3
  v_lshl_add_u32 v3, v2, 6, v3
  v_lshrrev_b32 v2, 5, v0
  v_lshl_add_u32 v3, v2, 4, v3
  v_lshrrev_b32 v2, 4, v0
  v_and_b32 v1, 15, v0
  v_lshlrev_b32 v1, 5, v1
  v_lshl_add_u32 v1, v2, 13, v1
  v_lshlrev_b32 v2, 3, v0
  v_add_u32 v2, 147456, v2
  v_mov_b32 v6, 155392
  s_waitcnt lgkmcnt(0)
  s_add_u32 s48, s48, 1
  s_and_b32 s48, s48, 0xff
  s_add_u32 s49, s48, 64
  s_and_b32 s49, s49, 0xff
  s_xor_b32 s50, s48, 0x80
  s_xor_b32 s51, s49, 0x80
  s_lshl_b32 s14, s49, 8
  s_or_b32 s14, s14, s48
  s_mul_i32 s14, s14, 0x10001
  s_xor_b32 s14, s14, 0x80800000
  s_waitcnt vmcnt(18)
  v_lshlrev_b32 v28, 16, v52
  v_and_b32 v29, 0xffff0000, v52
  v_lshlrev_b32 v30, 16, v53
  v_and_b32 v31, 0xffff0000, v53
  v_lshlrev_b32 v32, 16, v54
  v_and_b32 v33, 0xffff0000, v54
  v_lshlrev_b32 v34, 16, v55
  v_and_b32 v35, 0xffff0000, v55
  v_lshlrev_b32 v36, 16, v51
  v_and_b32 v37, 0xffff0000, v51
  v_add_f32 v38, v28, v29
  v_add_f32 v39, v30, v31
  v_add_f32 v38, v38, v32
  v_add_f32 v39, v39, v33
  v_add_f32 v38, v38, v34
  v_add_f32 v39, v39, v35
  v_add_f32 v38, v38, v36
  v_add_f32 v39, v39, v37
  v_add_f32 v38, v38, v39
  s_nop 1
  v_add_f32_dpp v38, v38, v38 quad_perm:[1,0,3,2] row_mask:0xf bank_mask:0xf
  s_nop 1
  v_add_f32_dpp v38, v38, v38 quad_perm:[2,3,0,1] row_mask:0xf bank_mask:0xf
  s_nop 1
  v_add_f32_dpp v38, v38, v38 row_half_mirror row_mask:0xf bank_mask:0xf
  s_nop 1
  v_add_f32_dpp v38, v38, v38 row_mirror row_mask:0xf bank_mask:0xf
  v_mov_b32 v39, v38
  s_nop 1
  v_permlane16_swap_b32 v38, v39
  v_add_f32 v38, v38, v39
  v_mov_b32 v39, v38
  s_nop 1
  v_permlane32_swap_b32 v38, v39
  v_add_f32 v38, v38, v39
  v_mul_f32 v38, 0x3ae38e39, v38
  v_sub_f32 v28, v28, v38
  v_sub_f32 v29, v29, v38
  v_sub_f32 v30, v30, v38
  v_sub_f32 v31, v31, v38
  v_sub_f32 v32, v32, v38
  v_sub_f32 v33, v33, v38
  v_sub_f32 v34, v34, v38
  v_sub_f32 v35, v35, v38
  v_sub_f32 v36, v36, v38
  v_sub_f32 v37, v37, v38
  v_cndmask_b32 v36, v36, 0, s[62:63]
  v_cndmask_b32 v37, v37, 0, s[62:63]
  v_mul_f32 v39, v28, v28
  v_mul_f32 v40, v29, v29
  v_fmac_f32 v39, v30, v30
  v_fmac_f32 v40, v31, v31
  v_fmac_f32 v39, v32, v32
  v_fmac_f32 v40, v33, v33
  v_fmac_f32 v39, v34, v34
  v_fmac_f32 v40, v35, v35
  v_fmac_f32 v39, v36, v36
  v_fmac_f32 v40, v37, v37
  v_add_f32 v39, v39, v40
  s_nop 1
  v_add_f32_dpp v39, v39, v39 quad_perm:[1,0,3,2] row_mask:0xf bank_mask:0xf
  s_nop 1
  v_add_f32_dpp v39, v39, v39 quad_perm:[2,3,0,1] row_mask:0xf bank_mask:0xf
  s_nop 1
  v_add_f32_dpp v39, v39, v39 row_half_mirror row_mask:0xf bank_mask:0xf
  s_nop 1
  v_add_f32_dpp v39, v39, v39 row_mirror row_mask:0xf bank_mask:0xf
  v_mov_b32 v40, v39
  s_nop 1
  v_permlane16_swap_b32 v39, v40
  v_add_f32 v39, v39, v40
  v_mov_b32 v40, v39
  s_nop 1
  v_permlane32_swap_b32 v39, v40
  v_add_f32 v39, v39, v40
  v_mul_f32 v39, 0x3ae38e39, v39
  v_cvt_pk_bf16_f32 v38, v38, v38
  v_lshlrev_b32 v38, 16, v38
  v_cvt_pk_bf16_f32 v39, v39, v39
  v_lshlrev_b32 v39, 16, v39
  v_add_f32 v39, 0x3727c5ac, v39
  v_cvt_pk_bf16_f32 v39, v39, v39
  v_lshlrev_b32 v39, 16, v39
  v_sqrt_f32 v39, v39
  s_nop 0
  v_cvt_pk_bf16_f32 v39, v39, v39
  v_lshlrev_b32 v39, 16, v39
  v_rcp_f32 v39, v39
  v_lshlrev_b32 v74, 16, v64
  v_and_b32 v75, 0xffff0000, v64
  v_lshlrev_b32 v76, 16, v65
  v_and_b32 v77, 0xffff0000, v65
  v_lshlrev_b32 v78, 16, v66
  v_and_b32 v79, 0xffff0000, v66
  v_lshlrev_b32 v80, 16, v67
  v_and_b32 v81, 0xffff0000, v67
  v_lshlrev_b32 v82, 16, v68
  v_and_b32 v83, 0xffff0000, v68
  v_lshlrev_b32 v84, 16, v69
  v_and_b32 v85, 0xffff0000, v69
  v_lshlrev_b32 v86, 16, v70
  v_and_b32 v87, 0xffff0000, v70
  v_lshlrev_b32 v88, 16, v71
  v_and_b32 v89, 0xffff0000, v71
  v_lshlrev_b32 v90, 16, v72
  v_and_b32 v91, 0xffff0000, v72
  v_sub_f32 v74, v74, v38
  v_sub_f32 v75, v75, v38
  v_sub_f32 v76, v76, v38
  v_sub_f32 v77, v77, v38
  v_sub_f32 v78, v78, v38
  v_sub_f32 v79, v79, v38
  v_sub_f32 v80, v80, v38
  v_sub_f32 v81, v81, v38
  v_sub_f32 v82, v82, v38
  v_sub_f32 v83, v83, v38
  v_sub_f32 v84, v84, v38
  v_sub_f32 v85, v85, v38
  v_sub_f32 v86, v86, v38
  v_sub_f32 v87, v87, v38
  v_sub_f32 v88, v88, v38
  v_sub_f32 v89, v89, v38
  v_sub_f32 v90, v90, v38
  v_sub_f32 v91, v91, v38
  v_cvt_pk_bf16_f32 v74, v74, v74
  v_cvt_pk_bf16_f32 v75, v75, v75
  v_cvt_pk_bf16_f32 v76, v76, v76
  v_cvt_pk_bf16_f32 v77, v77, v77
  v_cvt_pk_bf16_f32 v78, v78, v78
  v_cvt_pk_bf16_f32 v79, v79, v79
  v_cvt_pk_bf16_f32 v80, v80, v80
  v_cvt_pk_bf16_f32 v81, v81, v81
  v_cvt_pk_bf16_f32 v82, v82, v82
  v_cvt_pk_bf16_f32 v83, v83, v83
  v_cvt_pk_bf16_f32 v84, v84, v84
  v_cvt_pk_bf16_f32 v85, v85, v85
  v_cvt_pk_bf16_f32 v86, v86, v86
  v_cvt_pk_bf16_f32 v87, v87, v87
  v_cvt_pk_bf16_f32 v88, v88, v88
  v_cvt_pk_bf16_f32 v89, v89, v89
  v_cvt_pk_bf16_f32 v90, v90, v90
  v_cvt_pk_bf16_f32 v91, v91, v91
  v_lshlrev_b32 v74, 16, v74
  v_lshlrev_b32 v75, 16, v75
  v_lshlrev_b32 v76, 16, v76
  v_lshlrev_b32 v77, 16, v77
  v_lshlrev_b32 v78, 16, v78
  v_lshlrev_b32 v79, 16, v79
  v_lshlrev_b32 v80, 16, v80
  v_lshlrev_b32 v81, 16, v81
  v_lshlrev_b32 v82, 16, v82
  v_lshlrev_b32 v83, 16, v83
  v_lshlrev_b32 v84, 16, v84
  v_lshlrev_b32 v85, 16, v85
  v_lshlrev_b32 v86, 16, v86
  v_lshlrev_b32 v87, 16, v87
  v_lshlrev_b32 v88, 16, v88
  v_lshlrev_b32 v89, 16, v89
  v_lshlrev_b32 v90, 16, v90
  v_lshlrev_b32 v91, 16, v91
  v_mul_f32 v74, v74, v39
  v_mul_f32 v75, v75, v39
  v_mul_f32 v76, v76, v39
  v_mul_f32 v77, v77, v39
  v_mul_f32 v78, v78, v39
  v_mul_f32 v79, v79, v39
  v_mul_f32 v80, v80, v39
  v_mul_f32 v81, v81, v39
  v_mul_f32 v82, v82, v39
  v_mul_f32 v83, v83, v39
  v_mul_f32 v84, v84, v39
  v_mul_f32 v85, v85, v39
  v_mul_f32 v86, v86, v39
  v_mul_f32 v87, v87, v39
  v_mul_f32 v88, v88, v39
  v_mul_f32 v89, v89, v39
  v_mul_f32 v90, v90, v39
  v_mul_f32 v91, v91, v39
  v_cvt_pk_bf16_f32 v74, v74, v74
  v_cvt_pk_bf16_f32 v75, v75, v75
  v_cvt_pk_bf16_f32 v76, v76, v76
  v_cvt_pk_bf16_f32 v77, v77, v77
  v_cvt_pk_bf16_f32 v78, v78, v78
  v_cvt_pk_bf16_f32 v79, v79, v79
  v_cvt_pk_bf16_f32 v80, v80, v80
  v_cvt_pk_bf16_f32 v81, v81, v81
  v_cvt_pk_bf16_f32 v82, v82, v82
  v_cvt_pk_bf16_f32 v83, v83, v83
  v_cvt_pk_bf16_f32 v84, v84, v84
  v_cvt_pk_bf16_f32 v85, v85, v85
  v_cvt_pk_bf16_f32 v86, v86, v86
  v_cvt_pk_bf16_f32 v87, v87, v87
  v_cvt_pk_bf16_f32 v88, v88, v88
  v_cvt_pk_bf16_f32 v89, v89, v89
  v_cvt_pk_bf16_f32 v90, v90, v90
  v_cvt_pk_bf16_f32 v91, v91, v91
  v_and_b32 v36, v74, v8
  v_and_b32 v37, v74, v9
  v_and_b32 v38, v74, v10
  v_and_b32 v39, v74, v11
  v_and_b32 v40, v75, v8
  v_and_b32 v41, v75, v9
  v_and_b32 v42, v75, v10
  v_and_b32 v43, v75, v11
  s_waitcnt vmcnt(12)
  v_mfma_f32_16x16x32_bf16 v[60:63], v[36:39], v[100:103], 0
  v_and_b32 v36, v76, v8
  v_and_b32 v37, v76, v9
  v_and_b32 v38, v76, v10
  v_and_b32 v39, v76, v11
  v_mfma_f32_16x16x32_bf16 v[60:63], v[40:43], v[104:107], v[60:63]
  v_and_b32 v40, v77, v8
  v_and_b32 v41, v77, v9
  v_and_b32 v42, v77, v10
  v_and_b32 v43, v77, v11
  v_mfma_f32_16x16x32_bf16 v[60:63], v[36:39], v[108:111], v[60:63]
  v_and_b32 v36, v78, v8
  v_and_b32 v37, v78, v9
  v_and_b32 v38, v78, v10
  v_and_b32 v39, v78, v11
  v_mfma_f32_16x16x32_bf16 v[60:63], v[40:43], v[112:115], v[60:63]
  v_and_b32 v40, v79, v8
  v_and_b32 v41, v79, v9
  v_and_b32 v42, v79, v10
  v_and_b32 v43, v79, v11
  v_mfma_f32_16x16x32_bf16 v[60:63], v[36:39], v[116:119], v[60:63]
  v_and_b32 v36, v80, v8
  v_and_b32 v37, v80, v9
  v_and_b32 v38, v80, v10
  v_and_b32 v39, v80, v11
  v_mfma_f32_16x16x32_bf16 v[60:63], v[40:43], v[120:123], v[60:63]
  v_and_b32 v40, v81, v8
  v_and_b32 v41, v81, v9
  v_and_b32 v42, v81, v10
  v_and_b32 v43, v81, v11
  s_waitcnt vmcnt(6)
  v_mfma_f32_16x16x32_bf16 v[60:63], v[36:39], v[124:127], v[60:63]
  v_and_b32 v36, v82, v8
  v_and_b32 v37, v82, v9
  v_and_b32 v38, v82, v10
  v_and_b32 v39, v82, v11
  v_mfma_f32_16x16x32_bf16 v[60:63], v[40:43], v[128:131], v[60:63]
  v_and_b32 v40, v83, v8
  v_and_b32 v41, v83, v9
  v_and_b32 v42, v83, v10
  v_and_b32 v43, v83, v11
  v_mfma_f32_16x16x32_bf16 v[60:63], v[36:39], v[132:135], v[60:63]
  v_and_b32 v36, v84, v8
  v_and_b32 v37, v84, v9
  v_and_b32 v38, v84, v10
  v_and_b32 v39, v84, v11
  v_mfma_f32_16x16x32_bf16 v[60:63], v[40:43], v[136:139], v[60:63]
  v_and_b32 v40, v85, v8
  v_and_b32 v41, v85, v9
  v_and_b32 v42, v85, v10
  v_and_b32 v43, v85, v11
  v_mfma_f32_16x16x32_bf16 v[60:63], v[36:39], v[140:143], v[60:63]
  v_and_b32 v36, v86, v8
  v_and_b32 v37, v86, v9
  v_and_b32 v38, v86, v10
  v_and_b32 v39, v86, v11
  v_mfma_f32_16x16x32_bf16 v[60:63], v[40:43], v[144:147], v[60:63]
  v_and_b32 v40, v87, v8
  v_and_b32 v41, v87, v9
  v_and_b32 v42, v87, v10
  v_and_b32 v43, v87, v11
  s_waitcnt vmcnt(0)
  v_mfma_f32_16x16x32_bf16 v[60:63], v[36:39], v[148:151], v[60:63]
  v_and_b32 v36, v88, v8
  v_and_b32 v37, v88, v9
  v_and_b32 v38, v88, v10
  v_and_b32 v39, v88, v11
  v_mfma_f32_16x16x32_bf16 v[60:63], v[40:43], v[152:155], v[60:63]
  v_and_b32 v40, v89, v8
  v_and_b32 v41, v89, v9
  v_and_b32 v42, v89, v10
  v_and_b32 v43, v89, v11
  v_mfma_f32_16x16x32_bf16 v[60:63], v[36:39], v[156:159], v[60:63]
  v_and_b32 v36, v90, v8
  v_and_b32 v37, v90, v9
  v_and_b32 v38, v90, v10
  v_and_b32 v39, v90, v11
  v_mfma_f32_16x16x32_bf16 v[60:63], v[40:43], v[160:163], v[60:63]
  v_and_b32 v40, v91, v8
  v_and_b32 v41, v91, v9
  v_and_b32 v42, v91, v10
  v_and_b32 v43, v91, v11
  v_mfma_f32_16x16x32_bf16 v[60:63], v[36:39], v[164:167], v[60:63]
  s_nop 0
  v_mfma_f32_16x16x32_bf16 v[60:63], v[40:43], v[168:171], v[60:63]
  s_nop 7
  v_mov_b32 v56, v60
  v_mov_b32 v57, v61
  v_mov_b32 v58, v62
  v_mov_b32 v59, v63
  v_permlane32_swap_b32 v60, v56
  v_permlane32_swap_b32 v61, v57
  v_permlane32_swap_b32 v62, v58
  v_permlane32_swap_b32 v63, v59
  v_add_f32_dpp v28, v56, v60 row_ror:8 row_mask:0xf bank_mask:0xf
  v_add_f32_dpp v29, v57, v61 row_ror:8 row_mask:0xf bank_mask:0xf
  v_add_f32_dpp v30, v58, v62 row_ror:8 row_mask:0xf bank_mask:0xf
  v_add_f32_dpp v31, v59, v63 row_ror:8 row_mask:0xf bank_mask:0xf
  v_cndmask_b32 v32, v28, v30, s[62:63]
  v_mov_b32 v33, s14
  v_cndmask_b32 v34, v29, v31, s[62:63]
  v_mov_b32 v35, s14
  s_mov_b32 exec_lo, 0x00ff00ff
  s_mov_b32 exec_hi, 0x00ff00ff
  buffer_store_dwordx4 v[32:35], v3, s[44:47], s59 offen sc1
  s_mov_b64 exec, -1
  s_add_u32 s66, s60, 32768
  s_add_u32 s67, s60, 65536
  s_add_u32 s56, s60, 98304
  s_mov_b32 s58, 262144
  s_mov_b64 s[86:87], -1
  s_mov_b64 s[88:89], -1
  s_mov_b64 s[90:91], -1
  s_mov_b64 s[92:93], -1
  s_mov_b32 s58, 262144
L_pollq:
  s_sleep 48
  s_mov_b64 exec, s[86:87]
  s_cbranch_execz L_pollqs0
  buffer_load_dwordx4 v[64:67], v1, s[44:47], s60 offen sc1
  buffer_load_dwordx4 v[68:71], v1, s[44:47], s60 offen offset:16 sc1
L_pollqs0:
  s_mov_b64 exec, s[88:89]
  s_cbranch_execz L_pollqs1
  buffer_load_dwordx4 v[72:75], v1, s[44:47], s66 offen sc1
  buffer_load_dwordx4 v[76:79], v1, s[44:47], s66 offen offset:16 sc1
L_pollqs1:
  s_mov_b64 exec, s[90:91]
  s_cbranch_execz L_pollqs2
  buffer_load_dwordx4 v[80:83], v1, s[44:47], s67 offen sc1
  buffer_load_dwordx4 v[84:87], v1, s[44:47], s67 offen offset:16 sc1
L_pollqs2:
  s_mov_b64 exec, s[92:93]
  s_cbranch_execz L_pollqs3
  buffer_load_dwordx4 v[88:91], v1, s[44:47], s56 offen sc1
  buffer_load_dwordx4 v[92:95], v1, s[44:47], s56 offen offset:16 sc1
L_pollqs3:
  s_waitcnt vmcnt(0)
  s_mov_b64 exec, s[86:87]
  s_cbranch_execz L_pollqc0
  v_xor_b32 v65, s14, v65
  v_xor_b32 v67, s14, v67
  v_xor_b32 v69, s14, v69
  v_xor_b32 v71, s14, v71
  v_or3_b32 v47, v65, v67, v69
  v_or_b32 v47, v47, v71
  v_cmp_ne_u32 s[86:87], 0, v47
  s_nop 0
  s_lshr_b64 vcc, s[86:87], 4
  s_or_b64 s[86:87], s[86:87], vcc
  s_lshr_b64 vcc, s[86:87], 2
  s_or_b64 s[86:87], s[86:87], vcc
  s_lshr_b64 vcc, s[86:87], 1
  s_or_b64 s[86:87], s[86:87], vcc
  s_and_b32 s86, s86, 0x01010101
  s_and_b32 s87, s87, 0x01010101
  s_mul_i32 s86, s86, 0xff
  s_mul_i32 s87, s87, 0xff
L_pollqc0:
  s_mov_b64 exec, s[88:89]
  s_cbranch_execz L_pollqc1
  v_xor_b32 v73, s14, v73
  v_xor_b32 v75, s14, v75
  v_xor_b32 v77, s14, v77
  v_xor_b32 v79, s14, v79
  v_or3_b32 v48, v73, v75, v77
  v_or_b32 v48, v48, v79
  v_cmp_ne_u32 s[88:89], 0, v48
  s_nop 0
  s_lshr_b64 vcc, s[88:89], 4
  s_or_b64 s[88:89], s[88:89], vcc
  s_lshr_b64 vcc, s[88:89], 2
  s_or_b64 s[88:89], s[88:89], vcc
  s_lshr_b64 vcc, s[88:89], 1
  s_or_b64 s[88:89], s[88:89], vcc
  s_and_b32 s88, s88, 0x01010101
  s_and_b32 s89, s89, 0x01010101
  s_mul_i32 s88, s88, 0xff
  s_mul_i32 s89, s89, 0xff
L_pollqc1:
  s_mov_b64 exec, s[90:91]
  s_cbranch_execz L_pollqc2
  v_xor_b32 v81, s14, v81
  v_xor_b32 v83, s14, v83
  v_xor_b32 v85, s14, v85
  v_xor_b32 v87, s14, v87
  v_or3_b32 v49, v81, v83, v85
  v_or_b32 v49, v49, v87
  v_cmp_ne_u32 s[90:91], 0, v49
  s_nop 0
  s_lshr_b64 vcc, s[90:91], 4
  s_or_b64 s[90:91], s[90:91], vcc
  s_lshr_b64 vcc, s[90:91], 2
  s_or_b64 s[90:91], s[90:91], vcc
  s_lshr_b64 vcc, s[90:91], 1
  s_or_b64 s[90:91], s[90:91], vcc
  s_and_b32 s90, s90, 0x01010101
  s_and_b32 s91, s91, 0x01010101
  s_mul_i32 s90, s90, 0xff
  s_mul_i32 s91, s91, 0xff
L_pollqc2:
  s_mov_b64 exec, s[92:93]
  s_cbranch_execz L_pollqc3
  v_xor_b32 v89, s14, v89
  v_xor_b32 v91, s14, v91
  v_xor_b32 v93, s14, v93
  v_xor_b32 v95, s14, v95
  v_or3_b32 v47, v89, v91, v93
  v_or_b32 v47, v47, v95
  v_cmp_ne_u32 s[92:93], 0, v47
  s_nop 0
  s_lshr_b64 vcc, s[92:93], 4
  s_or_b64 s[92:93], s[92:93], vcc
  s_lshr_b64 vcc, s[92:93], 2
  s_or_b64 s[92:93], s[92:93], vcc
  s_lshr_b64 vcc, s[92:93], 1
  s_or_b64 s[92:93], s[92:93], vcc
  s_and_b32 s92, s92, 0x01010101
  s_and_b32 s93, s93, 0x01010101
  s_mul_i32 s92, s92, 0xff
  s_mul_i32 s93, s93, 0xff
L_pollqc3:
  s_mov_b64 exec, -1
  s_or_b64 vcc, s[86:87], s[88:89]
  s_or_b64 vcc, vcc, s[90:91]
  s_or_b64 vcc, vcc, s[92:93]
  s_cbranch_scc0 L_pollqd
  s_sub_u32 s58, s58, 1
  s_cbranch_scc0 L_pollq
L_pollqd:
L_gotq:
  v_add_f32 v64, v64, v72
  v_add_f32 v66, v66, v74
  v_add_f32 v68, v68, v76
  v_add_f32 v70, v70, v78
  v_add_f32 v80, v80, v88
  v_add_f32 v82, v82, v90
  v_add_f32 v84, v84, v92
  v_add_f32 v86, v86, v94
  v_add_f32 v64, v64, v80
  v_add_f32 v66, v66, v82
  v_add_f32 v68, v68, v84
  v_add_f32 v70, v70, v86
  v_cvt_pk_bf16_f32 v32, v64, v66
  v_cvt_pk_bf16_f32 v33, v68, v70
  ds_write_b64 v2, v[32:33]
  ds_write_b32 v6, v50 offset:36
  s_branch L_wait
L_notw0:
  s_setprio 2
  v_and_b32 v1, 15, v0
  v_lshrrev_b32 v2, 4, v0
  s_mul_i32 s56, s53, 36
  v_add_u32 v2, s56, v2
  s_mul_i32 s56, s52, 576
  s_bitcmp1_b32 s52, 0
  s_cselect_b32 s58, 64, 0
  s_cselect_b32 s66, 0, 512
  s_cmp_eq_u32 s3, 3
  s_cselect_b32 s67, 4, 16
  s_cselect_b32 s58, s66, s58
  s_cselect_b32 s55, 0, 256
  s_movk_i32 s54, 512
  s_cselect_b32 s54, 1152, s54
  s_lshl_b32 s66, s58, 1
  s_add_u32 s56, s56, s58
  s_add_u32 s57, s56, s55
  v_mul_u32_u24 v3, 9216, v2
  v_lshl_add_u32 v3, v1, 4, v3
  v_cmp_gt_u32 vcc, s67, v1
  v_mov_b32 v47, 0x7ff00000
  s_nop 0
  v_cndmask_b32 v3, v47, v3, vcc
  v_lshlrev_b32 v2, 1, v2
  s_mov_b32 s42, 5308416
  s_mov_b32 s30, 5308416
  s_mov_b32 s31, 0x20000
  s_waitcnt lgkmcnt(0)
  s_mov_b32 s36, s4
  s_mov_b32 s37, s5
  s_cmp_eq_u32 s3, 2
  s_cselect_b32 s40, s18, s16
  s_cselect_b32 s41, s19, s17
  s_cselect_b32 s58, 1152, 0
  s_add_u32 s66, s66, s58
  s_cmp_eq_u32 s3, 1
  s_cselect_b32 s28, s16, s18
  s_cselect_b32 s29, s17, s19
  s_load_dword s48, s[26:27], 0
  buffer_load_dwordx4 v[52:55], v7, s[36:39], 0 offen
  buffer_load_dword v51, v6, s[36:39], 0 offen offset:1024
  buffer_load_ushort v12, v2, s[36:39], 0 offen offset:0
  buffer_load_ushort v13, v2, s[36:39], 0 offen offset:8
  buffer_load_ushort v14, v2, s[36:39], 0 offen offset:16
  buffer_load_ushort v15, v2, s[36:39], 0 offen offset:24
  buffer_load_ushort v16, v2, s[36:39], 0 offen offset:32
  buffer_load_ushort v17, v2, s[36:39], 0 offen offset:40
  buffer_load_ushort v18, v2, s[36:39], 0 offen offset:48
  buffer_load_ushort v19, v2, s[36:39], 0 offen offset:56
  buffer_load_ushort v20, v2, s[36:39], 0 offen offset:64
  buffer_load_dwordx4 v[64:67], v3, s[40:43], s56 offen nt
  buffer_load_dwordx4 v[68:71], v3, s[28:31], s57 offen nt
  s_add_u32 s56, s56, 36864
  s_add_u32 s57, s57, 36864
  buffer_load_dwordx4 v[72:75], v3, s[40:43], s56 offen nt
  buffer_load_dwordx4 v[76:79], v3, s[28:31], s57 offen nt
  s_add_u32 s56, s56, 36864
  s_add_u32 s57, s57, 36864
  buffer_load_dwordx4 v[80:83], v3, s[40:43], s56 offen nt
  buffer_load_dwordx4 v[84:87], v3, s[28:31], s57 offen nt
  s_add_u32 s56, s56, 36864
  s_add_u32 s57, s57, 36864
  buffer_load_dwordx4 v[88:91], v3, s[40:43], s56 offen nt
  buffer_load_dwordx4 v[92:95], v3, s[28:31], s57 offen nt
  s_add_u32 s56, s56, 36864
  s_add_u32 s57, s57, 36864
  buffer_load_dwordx4 v[96:99], v3, s[40:43], s56 offen nt
  buffer_load_dwordx4 v[100:103], v3, s[28:31], s57 offen nt
  s_add_u32 s56, s56, 36864
  s_add_u32 s57, s57, 36864
  buffer_load_dwordx4 v[104:107], v3, s[40:43], s56 offen nt
  buffer_load_dwordx4 v[108:111], v3, s[28:31], s57 offen nt
  s_add_u32 s56, s56, 36864
  s_add_u32 s57, s57, 36864
  buffer_load_dwordx4 v[112:115], v3, s[40:43], s56 offen nt
  buffer_load_dwordx4 v[116:119], v3, s[28:31], s57 offen nt
  s_add_u32 s56, s56, 36864
  s_add_u32 s57, s57, 36864
  buffer_load_dwordx4 v[120:123], v3, s[40:43], s56 offen nt
  buffer_load_dwordx4 v[124:127], v3, s[28:31], s57 offen nt
  s_add_u32 s56, s56, 36864
  s_add_u32 s57, s57, 36864
  buffer_load_dwordx4 v[128:131], v3, s[40:43], s56 offen nt
  buffer_load_dwordx4 v[132:135], v3, s[28:31], s57 offen nt
  s_lshl_b32 s59, s2, 13
  s_lshl_b32 s60, s52, 17
  s_mov_b32 s62, 0
  s_mov_b32 s63, -1
  s_mov_b32 s64, 0x3fb8aa3b
  s_mov_b32 s65, 0x3db504f3
  s_add_u32 s44, s26, 65536
  s_addc_u32 s45, s27, 0
  s_mov_b32 s46, 2097152
  s_mov_b32 s47, 0x20000
  v_and_b32 v47, 1, v0
  v_lshlrev_b32 v47, 4, v47
  v_mov_b32 v48, 0xffff
  v_lshlrev_b32 v47, v47, v48
  v_bfe_u32 v48, v0, 1, 2
  v_cmp_eq_u32 vcc, 0, v48
  s_nop 1
  v_cndmask_b32 v8, 0, v47, vcc
  v_cmp_eq_u32 vcc, 1, v48
  s_nop 1
  v_cndmask_b32 v9, 0, v47, vcc
  v_cmp_eq_u32 vcc, 2, v48
  s_nop 1
  v_cndmask_b32 v10, 0, v47, vcc
  v_cmp_eq_u32 vcc, 3, v48
  s_nop 1
  v_cndmask_b32 v11, 0, v47, vcc
  v_mov_b32 v50, 0xff
  s_add_u32 s66, s66, s59
  v_cmp_gt_u32 vcc, s67, v1
  v_lshlrev_b32 v1, 5, v1
  v_bfe_u32 v2, v0, 4, 1
  v_lshl_add_u32 v1, v2, 4, v1
  v_lshrrev_b32 v2, 5, v0
  v_mad_u32_u24 v1, v2, s54, v1
  v_mov_b32 v2, 0x7ff00000
  v_cndmask_b32 v1, v2, v1, vcc
  s_waitcnt lgkmcnt(0)
  s_add_u32 s48, s48, 1
  s_and_b32 s48, s48, 0xff
  s_add_u32 s49, s48, 64
  s_and_b32 s49, s49, 0xff
  s_xor_b32 s50, s48, 0x80
  s_xor_b32 s51, s49, 0x80
  s_lshl_b32 s14, s49, 8
  s_or_b32 s14, s14, s48
  s_mul_i32 s14, s14, 0x10001
  s_xor_b32 s14, s14, 0x80800000
  s_waitcnt vmcnt(18)
  v_lshlrev_b32 v28, 16, v52
  v_and_b32 v29, 0xffff0000, v52
  v_lshlrev_b32 v30, 16, v53
  v_and_b32 v31, 0xffff0000, v53
  v_lshlrev_b32 v32, 16, v54
  v_and_b32 v33, 0xffff0000, v54
  v_lshlrev_b32 v34, 16, v55
  v_and_b32 v35, 0xffff0000, v55
  v_lshlrev_b32 v36, 16, v51
  v_and_b32 v37, 0xffff0000, v51
  v_add_f32 v38, v28, v29
  v_add_f32 v39, v30, v31
  v_add_f32 v38, v38, v32
  v_add_f32 v39, v39, v33
  v_add_f32 v38, v38, v34
  v_add_f32 v39, v39, v35
  v_add_f32 v38, v38, v36
  v_add_f32 v39, v39, v37
  v_add_f32 v38, v38, v39
  s_nop 1
  v_add_f32_dpp v38, v38, v38 quad_perm:[1,0,3,2] row_mask:0xf bank_mask:0xf
  s_nop 1
  v_add_f32_dpp v38, v38, v38 quad_perm:[2,3,0,1] row_mask:0xf bank_mask:0xf
  s_nop 1
  v_add_f32_dpp v38, v38, v38 row_half_mirror row_mask:0xf bank_mask:0xf
  s_nop 1
  v_add_f32_dpp v38, v38, v38 row_mirror row_mask:0xf bank_mask:0xf
  v_mov_b32 v39, v38
  s_nop 1
  v_permlane16_swap_b32 v38, v39
  v_add_f32 v38, v38, v39
  v_mov_b32 v39, v38
  s_nop 1
  v_permlane32_swap_b32 v38, v39
  v_add_f32 v38, v38, v39
  v_mul_f32 v38, 0x3ae38e39, v38
  v_sub_f32 v28, v28, v38
  v_sub_f32 v29, v29, v38
  v_sub_f32 v30, v30, v38
  v_sub_f32 v31, v31, v38
  v_sub_f32 v32, v32, v38
  v_sub_f32 v33, v33, v38
  v_sub_f32 v34, v34, v38
  v_sub_f32 v35, v35, v38
  v_sub_f32 v36, v36, v38
  v_sub_f32 v37, v37, v38
  v_cndmask_b32 v36, v36, 0, s[62:63]
  v_cndmask_b32 v37, v37, 0, s[62:63]
  v_mul_f32 v39, v28, v28
  v_mul_f32 v40, v29, v29
  v_fmac_f32 v39, v30, v30
  v_fmac_f32 v40, v31, v31
  v_fmac_f32 v39, v32, v32
  v_fmac_f32 v40, v33, v33
  v_fmac_f32 v39, v34, v34
  v_fmac_f32 v40, v35, v35
  v_fmac_f32 v39, v36, v36
  v_fmac_f32 v40, v37, v37
  v_add_f32 v39, v39, v40
  s_nop 1
  v_add_f32_dpp v39, v39, v39 quad_perm:[1,0,3,2] row_mask:0xf bank_mask:0xf
  s_nop 1
  v_add_f32_dpp v39, v39, v39 quad_perm:[2,3,0,1] row_mask:0xf bank_mask:0xf
  s_nop 1
  v_add_f32_dpp v39, v39, v39 row_half_mirror row_mask:0xf bank_mask:0xf
  s_nop 1
  v_add_f32_dpp v39, v39, v39 row_mirror row_mask:0xf bank_mask:0xf
  v_mov_b32 v40, v39
  s_nop 1
  v_permlane16_swap_b32 v39, v40
  v_add_f32 v39, v39, v40
  v_mov_b32 v40, v39
  s_nop 1
  v_permlane32_swap_b32 v39, v40
  v_add_f32 v39, v39, v40
  v_mul_f32 v39, 0x3ae38e39, v39
  v_cvt_pk_bf16_f32 v38, v38, v38
  v_lshlrev_b32 v38, 16, v38
  v_cvt_pk_bf16_f32 v39, v39, v39
  v_lshlrev_b32 v39, 16, v39
  v_add_f32 v39, 0x3727c5ac, v39
  v_cvt_pk_bf16_f32 v39, v39, v39
  v_lshlrev_b32 v39, 16, v39
  v_sqrt_f32 v39, v39
  s_nop 0
  v_cvt_pk_bf16_f32 v39, v39, v39
  v_lshlrev_b32 v39, 16, v39
  v_rcp_f32 v39, v39
  v_lshlrev_b32 v12, 16, v12
  v_lshlrev_b32 v13, 16, v13
  v_lshlrev_b32 v14, 16, v14
  v_lshlrev_b32 v15, 16, v15
  v_lshlrev_b32 v16, 16, v16
  v_lshlrev_b32 v17, 16, v17
  v_lshlrev_b32 v18, 16, v18
  v_lshlrev_b32 v19, 16, v19
  v_lshlrev_b32 v20, 16, v20
  v_sub_f32 v12, v12, v38
  v_sub_f32 v13, v13, v38
  v_sub_f32 v14, v14, v38
  v_sub_f32 v15, v15, v38
  v_sub_f32 v16, v16, v38
  v_sub_f32 v17, v17, v38
  v_sub_f32 v18, v18, v38
  v_sub_f32 v19, v19, v38
  v_sub_f32 v20, v20, v38
  v_cvt_pk_bf16_f32 v12, v12, v12
  v_cvt_pk_bf16_f32 v13, v13, v13
  v_cvt_pk_bf16_f32 v14, v14, v14
  v_cvt_pk_bf16_f32 v15, v15, v15
  v_cvt_pk_bf16_f32 v16, v16, v16
  v_cvt_pk_bf16_f32 v17, v17, v17
  v_cvt_pk_bf16_f32 v18, v18, v18
  v_cvt_pk_bf16_f32 v19, v19, v19
  v_cvt_pk_bf16_f32 v20, v20, v20
  v_lshlrev_b32 v12, 16, v12
  v_lshlrev_b32 v13, 16, v13
  v_lshlrev_b32 v14, 16, v14
  v_lshlrev_b32 v15, 16, v15
  v_lshlrev_b32 v16, 16, v16
  v_lshlrev_b32 v17, 16, v17
  v_lshlrev_b32 v18, 16, v18
  v_lshlrev_b32 v19, 16, v19
  v_lshlrev_b32 v20, 16, v20
  v_mul_f32 v12, v12, v39
  v_mul_f32 v13, v13, v39
  v_mul_f32 v14, v14, v39
  v_mul_f32 v15, v15, v39
  v_mul_f32 v16, v16, v39
  v_mul_f32 v17, v17, v39
  v_mul_f32 v18, v18, v39
  v_mul_f32 v19, v19, v39
  v_mul_f32 v20, v20, v39
  v_cvt_pk_bf16_f32 v12, v12, v12
  v_cvt_pk_bf16_f32 v13, v13, v13
  v_cvt_pk_bf16_f32 v14, v14, v14
  v_cvt_pk_bf16_f32 v15, v15, v15
  v_cvt_pk_bf16_f32 v16, v16, v16
  v_cvt_pk_bf16_f32 v17, v17, v17
  v_cvt_pk_bf16_f32 v18, v18, v18
  v_cvt_pk_bf16_f32 v19, v19, v19
  v_cvt_pk_bf16_f32 v20, v20, v20
  v_and_b32 v36, v12, v8
  v_and_b32 v37, v12, v9
  v_and_b32 v38, v12, v10
  v_and_b32 v39, v12, v11
  v_and_b32 v40, v13, v8
  v_and_b32 v41, v13, v9
  v_and_b32 v42, v13, v10
  v_and_b32 v43, v13, v11
  s_waitcnt vmcnt(12)
  v_mfma_f32_16x16x32_bf16 v[60:63], v[36:39], v[64:67], 0
  v_mfma_f32_16x16x32_bf16 v[56:59], v[36:39], v[68:71], 0
  v_and_b32 v36, v14, v8
  v_and_b32 v37, v14, v9
  v_and_b32 v38, v14, v10
  v_and_b32 v39, v14, v11
  v_mfma_f32_16x16x32_bf16 v[60:63], v[40:43], v[72:75], v[60:63]
  v_mfma_f32_16x16x32_bf16 v[56:59], v[40:43], v[76:79], v[56:59]
  v_and_b32 v40, v15, v8
  v_and_b32 v41, v15, v9
  v_and_b32 v42, v15, v10
  v_and_b32 v43, v15, v11
  v_mfma_f32_16x16x32_bf16 v[60:63], v[36:39], v[80:83], v[60:63]
  v_mfma_f32_16x16x32_bf16 v[56:59], v[36:39], v[84:87], v[56:59]
  v_and_b32 v36, v16, v8
  v_and_b32 v37, v16, v9
  v_and_b32 v38, v16, v10
  v_and_b32 v39, v16, v11
  s_waitcnt vmcnt(6)
  v_mfma_f32_16x16x32_bf16 v[60:63], v[40:43], v[88:91], v[60:63]
  v_mfma_f32_16x16x32_bf16 v[56:59], v[40:43], v[92:95], v[56:59]
  v_and_b32 v40, v17, v8
  v_and_b32 v41, v17, v9
  v_and_b32 v42, v17, v10
  v_and_b32 v43, v17, v11
  v_mfma_f32_16x16x32_bf16 v[60:63], v[36:39], v[96:99], v[60:63]
  v_mfma_f32_16x16x32_bf16 v[56:59], v[36:39], v[100:103], v[56:59]
  v_and_b32 v36, v18, v8
  v_and_b32 v37, v18, v9
  v_and_b32 v38, v18, v10
  v_and_b32 v39, v18, v11
  v_mfma_f32_16x16x32_bf16 v[60:63], v[40:43], v[104:107], v[60:63]
  v_mfma_f32_16x16x32_bf16 v[56:59], v[40:43], v[108:111], v[56:59]
  v_and_b32 v40, v19, v8
  v_and_b32 v41, v19, v9
  v_and_b32 v42, v19, v10
  v_and_b32 v43, v19, v11
  s_waitcnt vmcnt(0)
  v_mfma_f32_16x16x32_bf16 v[60:63], v[36:39], v[112:115], v[60:63]
  v_mfma_f32_16x16x32_bf16 v[56:59], v[36:39], v[116:119], v[56:59]
  v_and_b32 v36, v20, v8
  v_and_b32 v37, v20, v9
  v_and_b32 v38, v20, v10
  v_and_b32 v39, v20, v11
  v_mfma_f32_16x16x32_bf16 v[60:63], v[40:43], v[120:123], v[60:63]
  v_mfma_f32_16x16x32_bf16 v[56:59], v[40:43], v[124:127], v[56:59]
  v_mfma_f32_16x16x32_bf16 v[60:63], v[36:39], v[128:131], v[60:63]
  v_mfma_f32_16x16x32_bf16 v[56:59], v[36:39], v[132:135], v[56:59]
  s_nop 7
  v_cndmask_b32 v60, v60, v56, s[62:63]
  v_cndmask_b32 v61, v61, v57, s[62:63]
  v_cndmask_b32 v62, v62, v58, s[62:63]
  v_cndmask_b32 v63, v63, v59, s[62:63]
  v_bfi_b32 v60, v50, s48, v60
  v_bfi_b32 v61, v50, s49, v61
  v_bfi_b32 v62, v50, s50, v62
  v_bfi_b32 v63, v50, s51, v63
  buffer_store_dwordx4 v[60:63], v1, s[44:47], s66 offen offset:512 sc1
  s_cmp_eq_u32 s3, 1
  s_cbranch_scc1 L_g1
  s_branch L_wait
L_stream:
  s_setprio 1
  v_and_b32 v1, 15, v0
  v_lshrrev_b32 v2, 4, v0
  v_xor_b32 v3, v1, v2
  v_lshlrev_b32 v3, 4, v3
  v_lshl_add_u32 v64, v2, 8, v3
  v_xor_b32 v65, 64, v64
  v_xor_b32 v66, 0x80, v64
  v_xor_b32 v67, 0xc0, v64
  s_bfe_u32 s56, s3, 0x20000
  s_lshl_b32 s54, s56, 12
  s_bfe_u32 s56, s53, 0x10000
  s_lshl_b32 s56, s56, 16
  s_or_b32 s54, s54, s56
  s_bfe_u32 s56, s53, 0x10001
  s_lshl_b32 s56, s56, 14
  s_or_b32 s54, s54, s56
  s_bfe_u32 s56, s53, 0x10002
  s_lshl_b32 s56, s56, 19
  s_or_b32 s54, s54, s56
  s_bfe_u32 s56, s53, 0x10003
  s_lshl_b32 s56, s56, 21
  s_or_b32 s54, s54, s56
  s_mov_b32 s68, s54
  s_and_b32 s33, s3, 3
  s_mul_i32 s33, s33, 32768
  s_mov_b32 s69, 0
  s_mov_b32 s32, 0
  s_lshl_b32 s57, s52, 24
  s_mov_b32 s30, 0x1000000
  s_mov_b32 s31, 0x20000
  s_waitcnt lgkmcnt(0)
  s_add_u32 s28, s6, s57
  s_addc_u32 s29, s7, 0
  s_add_u32 s8, s8, s57
  s_addc_u32 s9, s9, 0
  s_mov_b32 s15, 0
  s_load_dword s48, s[26:27], 0
  s_mov_b32 s55, 2
L_pre:
  s_add_u32 m0, s33, s69
  s_add_u32 s69, s69, 4096
  s_and_b32 s69, s69, 32767
  s_waitcnt vmcnt(4)
  buffer_load_dwordx4 v64, s[28:31], s54 offen offset:0 nt lds
  s_waitcnt vmcnt(4)
  buffer_load_dwordx4 v65, s[28:31], s54 offen offset:1024 nt lds
  s_waitcnt vmcnt(4)
  buffer_load_dwordx4 v66, s[28:31], s54 offen offset:2048 nt lds
  s_waitcnt vmcnt(4)
  buffer_load_dwordx4 v67, s[28:31], s54 offen offset:3072 nt lds
  s_add_u32 s15, s15, 1
  s_mov_b32 s54, s68
  s_bfe_u32 s97, s15, 0x10000
  s_lshl_b32 s97, s97, 15
  s_or_b32 s54, s54, s97
  s_bfe_u32 s97, s15, 0x20001
  s_lshl_b32 s97, s97, 17
  s_or_b32 s54, s54, s97
  s_bfe_u32 s97, s15, 0x20003
  s_lshl_b32 s97, s97, 22
  s_or_b32 s54, s54, s97
  s_bfe_u32 s97, s15, 0x10005
  s_lshl_b32 s97, s97, 20
  s_or_b32 s54, s54, s97
  s_sub_u32 s55, s55, 1
  s_cmp_lg_u32 s55, 0
  s_cbranch_scc1 L_pre
  s_lshl_b32 s59, s2, 13
  s_lshl_b32 s60, s52, 17
  s_mov_b32 s62, 0
  s_mov_b32 s63, -1
  s_mov_b32 s64, 0x3fb8aa3b
  s_mov_b32 s65, 0x3db504f3
  s_add_u32 s44, s26, 65536
  s_addc_u32 s45, s27, 0
  s_mov_b32 s46, 2097152
  s_mov_b32 s47, 0x20000
  v_and_b32 v47, 1, v0
  v_lshlrev_b32 v47, 4, v47
  v_mov_b32 v48, 0xffff
  v_lshlrev_b32 v47, v47, v48
  v_bfe_u32 v48, v0, 1, 2
  v_cmp_eq_u32 vcc, 0, v48
  s_nop 1
  v_cndmask_b32 v8, 0, v47, vcc
  v_cmp_eq_u32 vcc, 1, v48
  s_nop 1
  v_cndmask_b32 v9, 0, v47, vcc
  v_cmp_eq_u32 vcc, 2, v48
  s_nop 1
  v_cndmask_b32 v10, 0, v47, vcc
  v_cmp_eq_u32 vcc, 3, v48
  s_nop 1
  v_cndmask_b32 v11, 0, v47, vcc
  v_mov_b32 v50, 0xff
  v_lshlrev_b32 v68, 4, v0
  v_lshl_add_u32 v69, v1, 8, v3
  v_add_u32 v69, s33, v69
  v_lshlrev_b32 v70, 4, v1
  v_lshl_add_u32 v70, v2, 10, v70
  v_add_u32 v70, s33, v70
  v_lshrrev_b32 v71, 3, v0
  v_lshlrev_b32 v71, 3, v71
  s_and_b32 s56, s3, 3
  s_lshl_b32 s56, s56, 12
  s_add_u32 s56, s56, 131072
  v_add_u32 v71, s56, v71
  v_mov_b32 v113, 155392
  s_and_b32 s56, s3, 3
  s_lshl_b32 s56, s56, 2
  s_add_u32 s56, s56, 155408
  v_mov_b32 v114, s56
  v_mov_b32 v115, 0
  v_add_u32 v118, 147968, v68
  s_and_b32 s57, s3, 3
  s_lshl_b32 s56, s57, 10
  v_add_u32 v116, s56, v118
  v_bfe_u32 v3, v0, 3, 1
  v_lshlrev_b32 v119, 3, v3
  v_add_u32 v119, 152064, v119
  s_lshl_b32 s56, s57, 4
  v_add_u32 v117, s56, v119
  v_lshrrev_b32 v120, 5, v0
  v_lshl_add_u32 v120, v3, 1, v120
  v_mul_u32_u24 v120, 256, v120
  v_bfe_u32 v3, v0, 4, 1
  v_and_b32 v121, 1, v0
  v_lshl_add_u32 v121, v121, 1, v3
  v_lshlrev_b32 v121, 3, v121
  v_lshl_add_u32 v120, v3, 7, v120
  v_and_b32 v3, 7, v0
  v_lshl_add_u32 v120, v3, 4, v120
  v_mov_b32 v7, 1
  s_mov_b32 s38, 0
  s_mov_b32 s39, 0
  s_and_b32 s56, s3, 3
  s_cmp_lt_u32 s56, 0
  s_cselect_b32 s34, 1, 0
  s_getreg_b32 s56, hwreg(HW_REG_XCC_ID, 0, 1)
  s_mov_b32 s35, 0xaa54aa54
  s_cmp_eq_u32 s56, 0
  s_cselect_b32 s36, s35, 0x88442210
  s_mov_b32 s37, s36
  s_lshr_b64 s[36:37], s[36:37], s3
  s_mov_b32 s35, s36
  s_waitcnt lgkmcnt(0)
  s_add_u32 s48, s48, 1
  s_and_b32 s48, s48, 0xff
  s_add_u32 s49, s48, 64
  s_and_b32 s49, s49, 0xff
  s_xor_b32 s50, s48, 0x80
  s_xor_b32 s51, s49, 0x80
  s_lshl_b32 s14, s49, 8
  s_or_b32 s14, s14, s48
  s_mul_i32 s14, s14, 0x10001
  s_xor_b32 s14, s14, 0x80800000
  s_mov_b32 s61, 0
  s_mov_b32 s58, 8388608
L_pre2:
  ds_read_b32 v1, v113 offset:36
  s_waitcnt lgkmcnt(0)
  v_readfirstlane_b32 s56, v1
  s_nop 0
  s_cmp_lg_u32 s56, 0
  s_cbranch_scc1 L_go
  s_cmp_ge_u32 s61, 12
  s_cbranch_scc1 L_prefull
  s_add_u32 m0, s33, s69
  s_add_u32 s69, s69, 4096
  s_and_b32 s69, s69, 32767
  s_waitcnt vmcnt(4)
  buffer_load_dwordx4 v64, s[28:31], s54 offen offset:0 nt lds
  s_waitcnt vmcnt(4)
  buffer_load_dwordx4 v65, s[28:31], s54 offen offset:1024 nt lds
  s_waitcnt vmcnt(4)
  buffer_load_dwordx4 v66, s[28:31], s54 offen offset:2048 nt lds
  s_waitcnt vmcnt(4)
  buffer_load_dwordx4 v67, s[28:31], s54 offen offset:3072 nt lds
  s_add_u32 s15, s15, 1
  s_mov_b32 s54, s68
  s_bfe_u32 s97, s15, 0x10000
  s_lshl_b32 s97, s97, 15
  s_or_b32 s54, s54, s97
  s_bfe_u32 s97, s15, 0x20001
  s_lshl_b32 s97, s97, 17
  s_or_b32 s54, s54, s97
  s_bfe_u32 s97, s15, 0x20003
  s_lshl_b32 s97, s97, 22
  s_or_b32 s54, s54, s97
  s_bfe_u32 s97, s15, 0x10005
  s_lshl_b32 s97, s97, 20
  s_or_b32 s54, s54, s97
  s_add_u32 s61, s61, 2
  s_branch L_pre2
L_prefull:
  s_sleep 2
  s_sub_u32 s58, s58, 1
  s_cbranch_scc0 L_pre2
L_go:
  v_bfe_u32 v1, v0, 3, 1
  v_lshlrev_b32 v1, 8, v1
  v_lshl_add_u32 v1, v2, 4, v1
  v_add_u32 v1, 147456, v1
  ds_read_b128 v[12:15], v1 offset:0
  ds_read_b128 v[16:19], v1 offset:64
  ds_read_b128 v[20:23], v1 offset:128
  ds_read_b128 v[24:27], v1 offset:192
  v_mov_b32 v28, 0
  v_mov_b32 v29, 0
  v_mov_b32 v30, 0
  v_mov_b32 v31, 0
  v_mov_b32 v46, 0xff167699
  v_mov_b32 v45, 0
  s_mov_b32 s55, 0
L_kloop:
  v_add_u32 v72, s32, v69
  v_xor_b32 v73, 64, v72
  v_xor_b32 v74, 0x80, v72
  v_xor_b32 v75, 0xc0, v72
  s_add_u32 s32, s32, 4096
  s_and_b32 s32, s32, 32767
  s_waitcnt vmcnt(4)
  ds_read_b128 v[76:79], v72
  ds_read_b128 v[80:83], v73
  ds_read_b128 v[84:87], v74
  ds_read_b128 v[88:91], v75
  ds_write_b32 v114, v115
  ds_read_b32 v112, v113 offset:32
  ds_read_b128 v[108:111], v113 offset:16
  s_cmp_lt_u32 s55, s61
  s_cselect_b32 s56, s55, 1
  s_bitcmp1_b32 s56, 0
  s_cbranch_scc0 L_knoiss
  s_add_u32 m0, s33, s69
  s_add_u32 s69, s69, 4096
  s_and_b32 s69, s69, 32767
  s_cmp_lg_u32 s38, 0
  s_cbranch_scc1 L_boost_1r
  s_cmp_lg_u32 s34, 0
  s_cbranch_scc1 L_boost_1
  s_waitcnt vmcnt(4)
  buffer_load_dwordx4 v64, s[28:31], s54 offen offset:0 nt lds
  s_waitcnt vmcnt(4)
  buffer_load_dwordx4 v65, s[28:31], s54 offen offset:1024 nt lds
  s_waitcnt vmcnt(4)
  buffer_load_dwordx4 v66, s[28:31], s54 offen offset:2048 nt lds
  s_waitcnt vmcnt(4)
  buffer_load_dwordx4 v67, s[28:31], s54 offen offset:3072 nt lds
L_boost_1b:
  s_add_u32 s15, s15, 1
  s_mov_b32 s54, s68
  s_bfe_u32 s97, s15, 0x10000
  s_lshl_b32 s97, s97, 15
  s_or_b32 s54, s54, s97
  s_bfe_u32 s97, s15, 0x20001
  s_lshl_b32 s97, s97, 17
  s_or_b32 s54, s54, s97
  s_bfe_u32 s97, s15, 0x20003
  s_lshl_b32 s97, s97, 22
  s_or_b32 s54, s54, s97
  s_bfe_u32 s97, s15, 0x10005
  s_lshl_b32 s97, s97, 20
  s_or_b32 s54, s54, s97
  s_cmp_eq_u32 s55, 61
  s_cbranch_scc1 L_kswitch
L_knoiss:
  s_waitcnt lgkmcnt(0)
  v_mfma_f32_16x16x32_bf16 v[32:35], v[76:79], v[12:15], 0
  v_mfma_f32_16x16x32_bf16 v[32:35], v[80:83], v[16:19], v[32:35]
  v_mfma_f32_16x16x32_bf16 v[32:35], v[84:87], v[20:23], v[32:35]
  v_mfma_f32_16x16x32_bf16 v[32:35], v[88:91], v[24:27], v[32:35]
  v_add3_u32 v108, v108, v109, v110
  v_lshl_add_u32 v109, v115, 2, 0
  v_add_u32 v108, v108, v111
  v_cmp_lt_u32 vcc, v109, v108
  v_readfirstlane_b32 s56, v112
  v_add_u32 v115, 1, v115
  s_and_b32 s57, s56, 0xffff
  s_cmp_lg_u32 s56, s39
  s_cselect_b32 s38, s57, s38
  s_mov_b32 s39, s56
  s_lshr_b32 s34, s35, s55
  s_and_b32 s34, s34, 1
  s_or_b32 s34, s34, vcc_lo
  s_add_u32 s55, s55, 1
  s_cmp_lt_u32 s55, 64
  v_cvt_pk_bf16_f32 v48, v32, v33
  v_cvt_pk_bf16_f32 v49, v34, v35
  v_lshlrev_b32 v32, 16, v48
  v_and_b32 v33, 0xffff0000, v48
  v_lshlrev_b32 v34, 16, v49
  v_and_b32 v35, 0xffff0000, v49
  v_mul_f32 v32, s65, v32
  v_mul_f32 v33, s65, v33
  v_mul_f32 v34, s65, v34
  v_mul_f32 v35, s65, v35
  v_cvt_pk_bf16_f32 v48, v32, v33
  v_cvt_pk_bf16_f32 v49, v34, v35
  ds_write_b64 v71, v[48:49]
  v_lshlrev_b32 v32, 16, v48
  v_and_b32 v33, 0xffff0000, v48
  v_lshlrev_b32 v34, 16, v49
  v_and_b32 v35, 0xffff0000, v49
  v_add_u32 v71, 64, v71
  v_max3_f32 v46, v46, v32, v33
  v_max3_f32 v46, v46, v34, v35
  s_cbranch_scc1 L_kloop
  v_mov_b32 v48, v46
  s_nop 1
  v_permlane16_swap_b32 v46, v48
  v_max_f32 v46, v46, v48
  v_mov_b32 v48, v46
  s_nop 1
  v_permlane32_swap_b32 v46, v48
  v_max_f32 v46, v46, v48
  v_mul_f32 v44, s64, v46
  v_subrev_u32 v71, 4096, v71
  s_mov_b32 s55, 0
  s_waitcnt lgkmcnt(0)
L_vloop:
  ds_read_b64 v[48:49], v71
  ds_write_b32 v114, v115
  ds_read_b32 v112, v113 offset:32
  ds_read_b128 v[108:111], v113 offset:16
  v_add_u32 v72, s32, v70
  v_add_u32 v71, 64, v71
  s_add_u32 s32, s32, 4096
  s_and_b32 s32, s32, 32767
  s_waitcnt lgkmcnt(0)
  v_lshlrev_b32 v32, 16, v48
  v_and_b32 v33, 0xffff0000, v48
  v_lshlrev_b32 v34, 16, v49
  v_and_b32 v35, 0xffff0000, v49
  v_add3_u32 v108, v108, v109, v110
  v_lshl_add_u32 v109, v115, 2, 0
  v_add_u32 v108, v108, v111
  v_cmp_lt_u32 vcc, v109, v108
  v_readfirstlane_b32 s56, v112
  v_add_u32 v115, 1, v115
  s_and_b32 s57, s56, 0xffff
  s_cmp_lg_u32 s56, s39
  s_cselect_b32 s38, s57, s38
  s_mov_b32 s39, s56
  s_lshr_b32 s34, s35, s55
  s_and_b32 s34, s34, 1
  s_or_b32 s34, s34, vcc_lo
  v_fma_f32 v32, v32, s64, -v44
  v_fma_f32 v33, v33, s64, -v44
  v_fma_f32 v34, v34, s64, -v44
  v_fma_f32 v35, v35, s64, -v44
  v_exp_f32 v32, v32
  v_exp_f32 v33, v33
  v_exp_f32 v34, v34
  v_exp_f32 v35, v35
  v_add_f32 v48, v32, v33
  v_add_f32 v49, v34, v35
  v_cvt_pk_bf16_f32 v32, v32, v32
  v_cvt_pk_bf16_f32 v33, v33, v33
  v_cvt_pk_bf16_f32 v34, v34, v34
  v_cvt_pk_bf16_f32 v35, v35, v35
  v_add_f32 v45, v45, v48
  v_add_f32 v45, v45, v49
  v_and_b32 v92, v32, v8
  v_and_b32 v93, v32, v9
  v_and_b32 v94, v32, v10
  v_and_b32 v95, v32, v11
  v_and_b32 v96, v33, v8
  v_and_b32 v97, v33, v9
  v_and_b32 v98, v33, v10
  v_and_b32 v99, v33, v11
  v_and_b32 v100, v34, v8
  v_and_b32 v101, v34, v9
  v_and_b32 v102, v34, v10
  v_and_b32 v103, v34, v11
  v_and_b32 v104, v35, v8
  v_and_b32 v105, v35, v9
  v_and_b32 v106, v35, v10
  v_and_b32 v107, v35, v11
  s_cmp_eq_u32 s55, 63
  s_cbranch_scc1 L_vlast
  s_waitcnt vmcnt(4)
L_vlastb:
  ds_read_b128 v[76:79], v72 offset:0
  ds_read_b128 v[80:83], v72 offset:256
  ds_read_b128 v[84:87], v72 offset:512
  ds_read_b128 v[88:91], v72 offset:768
  s_cmp_ge_u32 s55, 62
  s_cbranch_scc1 L_vnoiss
  s_add_u32 m0, s33, s69
  s_add_u32 s69, s69, 4096
  s_and_b32 s69, s69, 32767
  s_cmp_lg_u32 s38, 0
  s_cbranch_scc1 L_boost_2r
  s_cmp_lg_u32 s34, 0
  s_cbranch_scc1 L_boost_2
  s_waitcnt vmcnt(4)
  buffer_load_dwordx4 v64, s[28:31], s54 offen offset:0 nt lds
  s_waitcnt vmcnt(4)
  buffer_load_dwordx4 v65, s[28:31], s54 offen offset:1024 nt lds
  s_waitcnt vmcnt(4)
  buffer_load_dwordx4 v66, s[28:31], s54 offen offset:2048 nt lds
  s_waitcnt vmcnt(4)
  buffer_load_dwordx4 v67, s[28:31], s54 offen offset:3072 nt lds
L_boost_2b:
  s_add_u32 s15, s15, 1
  s_mov_b32 s54, s68
  s_bfe_u32 s97, s15, 0x10000
  s_lshl_b32 s97, s97, 15
  s_or_b32 s54, s54, s97
  s_bfe_u32 s97, s15, 0x20001
  s_lshl_b32 s97, s97, 17
  s_or_b32 s54, s54, s97
  s_bfe_u32 s97, s15, 0x20003
  s_lshl_b32 s97, s97, 22
  s_or_b32 s54, s54, s97
  s_bfe_u32 s97, s15, 0x10005
  s_lshl_b32 s97, s97, 20
  s_or_b32 s54, s54, s97
  s_cmp_eq_u32 s55, 61
  s_cbranch_scc1 L_late
L_vnoiss:
  s_add_u32 s55, s55, 1
  s_cmp_lt_u32 s55, 64
  s_waitcnt lgkmcnt(3)
  v_mfma_f32_16x16x32_bf16 v[28:31], v[76:79], v[92:95], v[28:31]
  s_waitcnt lgkmcnt(2)
  v_mfma_f32_16x16x32_bf16 v[28:31], v[80:83], v[96:99], v[28:31]
  s_waitcnt lgkmcnt(1)
  v_mfma_f32_16x16x32_bf16 v[28:31], v[84:87], v[100:103], v[28:31]
  s_waitcnt lgkmcnt(0)
  v_mfma_f32_16x16x32_bf16 v[28:31], v[88:91], v[104:107], v[28:31]
  s_cbranch_scc1 L_vloop
  s_branch L_post
L_kswitch:
  s_mov_b32 s28, s8
  s_mov_b32 s29, s9
  s_mov_b32 s54, s68
  v_mov_b32 v64, v68
  v_mov_b32 v65, v68
  v_mov_b32 v66, v68
  v_mov_b32 v67, v68
  s_branch L_knoiss
L_vlast:
  s_waitcnt vmcnt(0)
  s_branch L_vlastb
L_late:
  s_mov_b64 exec, 1
  ds_add_u32 v113, v7
  s_mov_b64 exec, -1
  s_waitcnt lgkmcnt(0)
  s_branch L_vnoiss
L_boost_1r:
  s_sub_u32 s38, s38, 1
  s_waitcnt vmcnt(7)
  buffer_load_dwordx4 v64, s[28:31], s54 offen offset:0 nt lds
  s_waitcnt vmcnt(7)
  buffer_load_dwordx4 v65, s[28:31], s54 offen offset:1024 nt lds
  s_waitcnt vmcnt(7)
  buffer_load_dwordx4 v66, s[28:31], s54 offen offset:2048 nt lds
  s_waitcnt vmcnt(7)
  buffer_load_dwordx4 v67, s[28:31], s54 offen offset:3072 nt lds
  s_branch L_boost_1b
L_boost_1:
  s_waitcnt vmcnt(5)
  buffer_load_dwordx4 v64, s[28:31], s54 offen offset:0 nt lds
  s_waitcnt vmcnt(5)
  buffer_load_dwordx4 v65, s[28:31], s54 offen offset:1024 nt lds
  s_waitcnt vmcnt(5)
  buffer_load_dwordx4 v66, s[28:31], s54 offen offset:2048 nt lds
  s_waitcnt vmcnt(5)
  buffer_load_dwordx4 v67, s[28:31], s54 offen offset:3072 nt lds
  s_branch L_boost_1b
L_boost_2r:
  s_sub_u32 s38, s38, 1
  s_waitcnt vmcnt(7)
  buffer_load_dwordx4 v64, s[28:31], s54 offen offset:0 nt lds
  s_waitcnt vmcnt(7)
  buffer_load_dwordx4 v65, s[28:31], s54 offen offset:1024 nt lds
  s_waitcnt vmcnt(7)
  buffer_load_dwordx4 v66, s[28:31], s54 offen offset:2048 nt lds
  s_waitcnt vmcnt(7)
  buffer_load_dwordx4 v67, s[28:31], s54 offen offset:3072 nt lds
  s_branch L_boost_2b
L_boost_2:
  s_waitcnt vmcnt(5)
  buffer_load_dwordx4 v64, s[28:31], s54 offen offset:0 nt lds
  s_waitcnt vmcnt(5)
  buffer_load_dwordx4 v65, s[28:31], s54 offen offset:1024 nt lds
  s_waitcnt vmcnt(5)
  buffer_load_dwordx4 v66, s[28:31], s54 offen offset:2048 nt lds
  s_waitcnt vmcnt(5)
  buffer_load_dwordx4 v67, s[28:31], s54 offen offset:3072 nt lds
  s_branch L_boost_2b
L_post:
  v_mov_b32 v48, v45
  s_nop 1
  v_permlane16_swap_b32 v45, v48
  v_add_f32 v45, v45, v48
  v_mov_b32 v48, v45
  s_nop 1
  v_permlane32_swap_b32 v45, v48
  v_add_f32 v45, v45, v48
  ds_write_b128 v116, v[28:31]
  ds_write_b64 v117, v[44:45]
  s_mov_b64 exec, 1
  ds_add_rtn_u32 v7, v113, v7 offset:8
  s_mov_b64 exec, -1
  ds_read_b64 v[64:65], v119 offset:0
  ds_read_b64 v[66:67], v119 offset:16
  ds_read_b64 v[68:69], v119 offset:32
  ds_read_b64 v[70:71], v119 offset:48
  ds_read_b128 v[80:83], v118 offset:0
  ds_read_b128 v[84:87], v118 offset:1024
  ds_read_b128 v[88:91], v118 offset:2048
  ds_read_b128 v[92:95], v118 offset:3072
  s_waitcnt lgkmcnt(8)
  v_readfirstlane_b32 s56, v7
  s_nop 0
  s_cmp_eq_u32 s56, 0
  s_cbranch_scc1 L_g2
  s_cmp_eq_u32 s56, 3
  s_cbranch_scc0 L_end
  s_waitcnt lgkmcnt(4)
  v_max3_f32 v32, v64, v66, v68
  v_max_f32 v32, v32, v70
  v_sub_f32 v64, v64, v32
  v_sub_f32 v66, v66, v32
  v_sub_f32 v68, v68, v32
  v_sub_f32 v70, v70, v32
  v_exp_f32 v64, v64
  v_exp_f32 v66, v66
  v_exp_f32 v68, v68
  v_exp_f32 v70, v70
  v_mul_f32 v33, v64, v65
  v_fmac_f32 v33, v66, v67
  v_fmac_f32 v33, v68, v69
  v_fmac_f32 v33, v70, v71
  v_max_f32 v33, 0x03800000, v33
  v_rcp_f32 v34, v33
  v_log_f32 v33, v33
  v_mul_f32 v64, v64, v34
  v_mul_f32 v66, v66, v34
  v_mul_f32 v68, v68, v34
  v_mul_f32 v70, v70, v34
  v_add_f32 v32, v32, v33
  v_lshrrev_b32 v32, v121, v32
  s_waitcnt lgkmcnt(0)
  v_mul_f32 v28, v64, v80
  v_mul_f32 v29, v64, v81
  v_mul_f32 v30, v64, v82
  v_mul_f32 v31, v64, v83
  v_fmac_f32 v28, v66, v84
  v_fmac_f32 v29, v66, v85
  v_fmac_f32 v30, v66, v86
  v_fmac_f32 v31, v66, v87
  v_fmac_f32 v28, v68, v88
  v_fmac_f32 v29, v68, v89
  v_fmac_f32 v30, v68, v90
  v_fmac_f32 v31, v68, v91
  v_fmac_f32 v28, v70, v92
  v_fmac_f32 v29, v70, v93
  v_fmac_f32 v30, v70, v94
  v_fmac_f32 v31, v70, v95
  v_bfi_b32 v28, v50, s48, v28
  v_bfi_b32 v29, v50, s49, v29
  v_bfi_b32 v30, v50, s50, v30
  v_bfi_b32 v31, v50, v32, v31
  buffer_store_dwordx4 v[28:31], v120, s[44:47], s59 offen offset:2816 sc1
  s_mov_b64 exec, 1
  v_mov_b32 v7, 1
  ds_add_u32 v113, v7 offset:8
  s_endpgm
L_g2:
  s_endpgm
L_g1:
  v_lshrrev_b32 v1, 3, v0
  v_and_b32 v2, 7, v0
  s_lshl_b32 s66, s53, 3
  s_lshl_b32 s56, s53, 5
  s_sub_u32 s56, s56, 216
  s_cmp_eq_u32 s53, 15
  s_cselect_b32 s67, 6, 8
  s_cmp_lt_u32 s53, 9
  s_cselect_b32 s67, 2, s67
  s_cselect_b32 s66, s66, s56
  v_cmp_gt_u32 vcc, s67, v1
  s_nop 1
  v_cndmask_b32 v7, 0, v1, vcc
  v_lshlrev_b32 v7, 4, v7
  v_lshl_add_u32 v7, v2, 13, v7
  s_lshl_b32 s56, s66, 2
  s_add_u32 s56, s56, s60
  s_add_u32 s57, s56, 65536
  s_mov_b64 s[86:87], -1
  s_mov_b64 s[88:89], -1
  s_mov_b32 s58, 262144
L_pollgu:
  s_sleep 64
  s_mov_b64 exec, s[86:87]
  s_cbranch_execz L_pollgus0
  buffer_load_dwordx4 v[112:115], v7, s[44:47], s56 offen offset:512 sc1
  buffer_load_dwordx4 v[116:119], v7, s[44:47], s56 offen offset:1664 sc1
L_pollgus0:
  s_mov_b64 exec, s[88:89]
  s_cbranch_execz L_pollgus1
  buffer_load_dwordx4 v[120:123], v7, s[44:47], s57 offen offset:512 sc1
  buffer_load_dwordx4 v[124:127], v7, s[44:47], s57 offen offset:1664 sc1
L_pollgus1:
  s_waitcnt vmcnt(0)
  s_mov_b64 exec, s[86:87]
  s_cbranch_execz L_pollguc0
  v_xor_b32 v112, s48, v112
  v_xor_b32 v113, s49, v113
  v_xor_b32 v114, s50, v114
  v_xor_b32 v115, s51, v115
  v_xor_b32 v116, s48, v116
  v_xor_b32 v117, s49, v117
  v_xor_b32 v118, s50, v118
  v_xor_b32 v119, s51, v119
  v_or3_b32 v47, v112, v113, v114
  v_or3_b32 v47, v47, v115, v116
  v_or3_b32 v47, v47, v117, v118
  v_or_b32 v47, v47, v119
  v_and_b32 v47, 0xff, v47
  v_cmp_ne_u32 s[86:87], 0, v47
  s_nop 0
  s_or_b32 vcc_lo, s86, s87
  s_lshr_b32 vcc_hi, vcc_lo, 16
  s_or_b32 vcc_lo, vcc_lo, vcc_hi
  s_lshr_b32 vcc_hi, vcc_lo, 8
  s_or_b32 vcc_lo, vcc_lo, vcc_hi
  s_and_b32 vcc_lo, vcc_lo, 0xff
  s_mul_i32 s86, vcc_lo, 0x01010101
  s_mov_b32 s87, s86
L_pollguc0:
  s_mov_b64 exec, s[88:89]
  s_cbranch_execz L_pollguc1
  v_xor_b32 v120, s48, v120
  v_xor_b32 v121, s49, v121
  v_xor_b32 v122, s50, v122
  v_xor_b32 v123, s51, v123
  v_xor_b32 v124, s48, v124
  v_xor_b32 v125, s49, v125
  v_xor_b32 v126, s50, v126
  v_xor_b32 v127, s51, v127
  v_or3_b32 v48, v120, v121, v122
  v_or3_b32 v48, v48, v123, v124
  v_or3_b32 v48, v48, v125, v126
  v_or_b32 v48, v48, v127
  v_and_b32 v48, 0xff, v48
  v_cmp_ne_u32 s[88:89], 0, v48
  s_nop 0
  s_or_b32 vcc_lo, s88, s89
  s_lshr_b32 vcc_hi, vcc_lo, 16
  s_or_b32 vcc_lo, vcc_lo, vcc_hi
  s_lshr_b32 vcc_hi, vcc_lo, 8
  s_or_b32 vcc_lo, vcc_lo, vcc_hi
  s_and_b32 vcc_lo, vcc_lo, 0xff
  s_mul_i32 s88, vcc_lo, 0x01010101
  s_mov_b32 s89, s88
L_pollguc1:
  s_mov_b64 exec, -1
  s_or_b64 vcc, s[86:87], s[88:89]
  s_cbranch_scc0 L_pollgud
  s_sub_u32 s58, s58, 1
  s_cbranch_scc0 L_pollgu
L_pollgud:
  v_add_f32 v112, v112, v120
  v_add_f32 v113, v113, v121
  v_add_f32 v114, v114, v122
  v_add_f32 v115, v115, v123
  v_add_f32 v116, v116, v124
  v_add_f32 v117, v117, v125
  v_add_f32 v118, v118, v126
  v_add_f32 v119, v119, v127
  v_add_f32_dpp v112, v112, v112 quad_perm:[1,0,3,2] row_mask:0xf bank_mask:0xf
  v_add_f32_dpp v113, v113, v113 quad_perm:[1,0,3,2] row_mask:0xf bank_mask:0xf
  v_add_f32_dpp v114, v114, v114 quad_perm:[1,0,3,2] row_mask:0xf bank_mask:0xf
  v_add_f32_dpp v115, v115, v115 quad_perm:[1,0,3,2] row_mask:0xf bank_mask:0xf
  v_add_f32_dpp v116, v116, v116 quad_perm:[1,0,3,2] row_mask:0xf bank_mask:0xf
  v_add_f32_dpp v117, v117, v117 quad_perm:[1,0,3,2] row_mask:0xf bank_mask:0xf
  v_add_f32_dpp v118, v118, v118 quad_perm:[1,0,3,2] row_mask:0xf bank_mask:0xf
  v_add_f32_dpp v119, v119, v119 quad_perm:[1,0,3,2] row_mask:0xf bank_mask:0xf
  v_add_f32_dpp v112, v112, v112 quad_perm:[2,3,0,1] row_mask:0xf bank_mask:0xf
  v_add_f32_dpp v113, v113, v113 quad_perm:[2,3,0,1] row_mask:0xf bank_mask:0xf
  v_add_f32_dpp v114, v114, v114 quad_perm:[2,3,0,1] row_mask:0xf bank_mask:0xf
  v_add_f32_dpp v115, v115, v115 quad_perm:[2,3,0,1] row_mask:0xf bank_mask:0xf
  v_add_f32_dpp v116, v116, v116 quad_perm:[2,3,0,1] row_mask:0xf bank_mask:0xf
  v_add_f32_dpp v117, v117, v117 quad_perm:[2,3,0,1] row_mask:0xf bank_mask:0xf
  v_add_f32_dpp v118, v118, v118 quad_perm:[2,3,0,1] row_mask:0xf bank_mask:0xf
  v_add_f32_dpp v119, v119, v119 quad_perm:[2,3,0,1] row_mask:0xf bank_mask:0xf
  v_add_f32_dpp v112, v112, v112 row_half_mirror row_mask:0xf bank_mask:0xf
  v_add_f32_dpp v113, v113, v113 row_half_mirror row_mask:0xf bank_mask:0xf
  v_add_f32_dpp v114, v114, v114 row_half_mirror row_mask:0xf bank_mask:0xf
  v_add_f32_dpp v115, v115, v115 row_half_mirror row_mask:0xf bank_mask:0xf
  v_add_f32_dpp v116, v116, v116 row_half_mirror row_mask:0xf bank_mask:0xf
  v_add_f32_dpp v117, v117, v117 row_half_mirror row_mask:0xf bank_mask:0xf
  v_add_f32_dpp v118, v118, v118 row_half_mirror row_mask:0xf bank_mask:0xf
  v_add_f32_dpp v119, v119, v119 row_half_mirror row_mask:0xf bank_mask:0xf
  v_cvt_pk_bf16_f32 v112, v112, v112
  v_lshlrev_b32 v112, 16, v112
  v_cvt_pk_bf16_f32 v113, v113, v113
  v_lshlrev_b32 v113, 16, v113
  v_cvt_pk_bf16_f32 v114, v114, v114
  v_lshlrev_b32 v114, 16, v114
  v_cvt_pk_bf16_f32 v115, v115, v115
  v_lshlrev_b32 v115, 16, v115
  v_cvt_pk_bf16_f32 v116, v116, v116
  v_lshlrev_b32 v116, 16, v116
  v_cvt_pk_bf16_f32 v117, v117, v117
  v_lshlrev_b32 v117, 16, v117
  v_cvt_pk_bf16_f32 v118, v118, v118
  v_lshlrev_b32 v118, 16, v118
  v_cvt_pk_bf16_f32 v119, v119, v119
  v_lshlrev_b32 v119, 16, v119
  v_mul_f32 v112, s64, v112
  v_mul_f32 v113, s64, v113
  v_mul_f32 v114, s64, v114
  v_mul_f32 v115, s64, v115
  v_exp_f32 v112, -v112
  v_exp_f32 v113, -v113
  v_exp_f32 v114, -v114
  v_exp_f32 v115, -v115
  v_add_f32 v112, 1.0, v112
  v_add_f32 v113, 1.0, v113
  v_add_f32 v114, 1.0, v114
  v_add_f32 v115, 1.0, v115
  v_rcp_f32 v112, v112
  v_rcp_f32 v113, v113
  v_rcp_f32 v114, v114
  v_rcp_f32 v115, v115
  v_cvt_pk_bf16_f32 v112, v112, v112
  v_lshlrev_b32 v112, 16, v112
  v_cvt_pk_bf16_f32 v113, v113, v113
  v_lshlrev_b32 v113, 16, v113
  v_cvt_pk_bf16_f32 v114, v114, v114
  v_lshlrev_b32 v114, 16, v114
  v_cvt_pk_bf16_f32 v115, v115, v115
  v_lshlrev_b32 v115, 16, v115
  v_mul_f32 v112, v112, v116
  v_mul_f32 v113, v113, v117
  v_mul_f32 v114, v114, v118
  v_mul_f32 v115, v115, v119
  v_cvt_pk_bf16_f32 v112, v112, v112
  v_cvt_pk_bf16_f32 v113, v113, v113
  v_cvt_pk_bf16_f32 v114, v114, v114
  v_cvt_pk_bf16_f32 v115, v115, v115
  v_lshlrev_b32 v6, 4, v1
  v_add_u32 v6, 155264, v6
  ds_write_b128 v6, v[112:115]
  v_mov_b32 v6, 155392
  v_mov_b32 v7, 1
  s_waitcnt lgkmcnt(0)
  ds_write_b32 v6, v7 offset:4
L_wait:
  v_lshrrev_b32 v1, 3, v0
  v_and_b32 v2, 7, v0
  s_lshl_b32 s66, s53, 3
  s_lshl_b32 s56, s53, 5
  s_sub_u32 s56, s56, 216
  s_cmp_eq_u32 s53, 15
  s_cselect_b32 s67, 6, 8
  s_cmp_lt_u32 s53, 9
  s_cselect_b32 s67, 2, s67
  s_cselect_b32 s66, s66, s56
  v_cmp_gt_u32 vcc, s67, v1
  s_mov_b32 s40, s20
  s_mov_b32 s41, s21
  s_mov_b32 s42, 5308416
  s_mov_b32 s43, 0x20000
  s_mov_b32 s28, s12
  s_mov_b32 s29, s13
  s_mov_b32 s30, 4718592
  s_mov_b32 s31, 0x20000
  v_mul_u32_u24 v4, 4608, v1
  v_lshl_add_u32 v4, v2, 4, v4
  v_mov_b32 v6, 0x7ff00000
  v_cndmask_b32 v4, v6, v4, vcc
  s_mul_i32 s56, s52, 288
  s_add_u32 s56, s56, s66
  s_mul_i32 s56, s56, 1152
  s_lshl_b32 s57, s3, 7
  s_add_u32 s32, s56, s57
  v_mul_u32_u24 v5, 1152, v1
  v_lshl_add_u32 v5, v2, 4, v5
  s_lshl_b32 s56, s52, 2
  s_add_u32 s56, s56, s3
  s_mul_i32 s56, s56, 73728
  s_lshl_b32 s57, s53, 7
  s_add_u32 s33, s56, s57
  v_bfe_u32 v3, v0, 4, 1
  v_lshlrev_b32 v3, 4, v3
  v_lshl_add_u32 v3, v2, 5, v3
  v_lshrrev_b32 v20, 4, v0
  v_lshlrev_b32 v19, 3, v20
  v_lshrrev_b32 v19, v19, s14
  v_and_b32 v47, 15, v0
  v_lshl_add_u32 v20, v47, 2, v20
  v_lshlrev_b32 v20, 2, v20
  v_lshrrev_b32 v21, 5, v0
  v_lshl_add_u32 v21, v21, 10, v3
  v_lshrrev_b32 v6, 1, v20
  buffer_load_ushort v12, v6, s[36:39], s57 offen
  v_mov_b32 v17, 1
  v_lshlrev_b32 v18, 4, v0
  v_add_u32 v18, 152192, v18
  v_lshlrev_b32 v14, 13, v2
  v_lshl_add_u32 v15, v1, 4, v14
  v_lshrrev_b32 v16, 5, v0
  v_lshl_add_u32 v16, v16, 8, v3
  s_lshl_b32 s56, s3, 9
  s_add_u32 s56, s56, 152192
  v_add_u32 v16, s56, v16
  s_mul_i32 s34, s3, 256
  s_add_u32 s34, s34, s60
  v_lshlrev_b32 v6, 4, v1
  v_add_u32 v6, 155264, v6
  v_mov_b32 v7, 155392
  s_mov_b32 s58, 8388608
L_pollh:
  s_sleep 4
  ds_read_b32 v47, v7 offset:4
  s_waitcnt lgkmcnt(0)
  v_readfirstlane_b32 s56, v47
  s_nop 0
  s_cmp_lg_u32 s56, 0
  s_cbranch_scc1 L_goth
  s_sub_u32 s58, s58, 1
  s_cbranch_scc0 L_pollh
L_goth:
  ds_read_b128 v[112:115], v6
  s_waitcnt lgkmcnt(0)
  v_and_b32 v36, v112, v8
  v_and_b32 v37, v112, v9
  v_and_b32 v38, v112, v10
  v_and_b32 v39, v112, v11
  v_and_b32 v40, v113, v8
  v_and_b32 v41, v113, v9
  v_and_b32 v42, v113, v10
  v_and_b32 v43, v113, v11
  v_and_b32 v32, v114, v8
  v_and_b32 v33, v114, v9
  v_and_b32 v34, v114, v10
  v_and_b32 v35, v114, v11
  v_and_b32 v120, v115, v8
  v_and_b32 v121, v115, v9
  v_and_b32 v122, v115, v10
  v_and_b32 v123, v115, v11
  s_cmp_eq_u32 s3, 2
  s_cbranch_scc0 L_nolag
  s_mov_b32 s86, 0xe078f1e0
  s_mov_b32 s87, 0x7fe78781
  s_mov_b32 s88, 0x40102040
  s_mov_b32 s89, 0x14410100
  s_mov_b32 s90, 0
  s_mov_b32 s92, 0
  s_and_b32 s66, s14, 0xffff0000
  s_lshl_b32 s67, s96, 13
  s_add_u32 s67, s67, 7168
  s_and_b32 s93, s96, 7
  s_lshl_b32 s93, s93, 13
  s_add_u32 s93, s93, 7168
  v_and_b32 v22, 31, v0
  v_lshlrev_b32 v22, 16, v22
  v_mov_b32 v23, 0
  s_mov_b32 s58, 8388608
L_lag:
  s_sleep 6
  s_sub_u32 s58, s58, 1
  s_cbranch_scc1 L_nolag
  ds_read_b128 v[24:27], v7 offset:16
  s_waitcnt lgkmcnt(0)
  v_add3_u32 v24, v24, v25, v26
  v_add_u32 v24, v24, v27
  s_nop 0
  v_readfirstlane_b32 s91, v24
  s_nop 0
  s_cmp_ge_u32 s91, 504
  s_cbranch_scc1 L_nolag
  s_lshr_b32 s56, s91, 3
  s_cmp_eq_u32 s56, s90
  s_cbranch_scc1 L_lag
  s_mov_b32 s90, s56
  s_bitcmp1_b64 s[86:87], s56
  s_cbranch_scc0 L_lag
  s_lshl_b32 s57, s56, 3
  s_or_b32 s57, s57, s66
  v_mov_b32 v25, s57
  s_mov_b64 exec, 1
  buffer_store_dword v25, v23, s[44:47], s67 offen
  s_mov_b64 exec, -1
  s_bitcmp1_b64 s[88:89], s56
  s_cbranch_scc0 L_lagn
  s_mov_b32 exec_lo, 0xffffffff
  s_mov_b32 exec_hi, 0
  buffer_load_dword v26, v22, s[44:47], s93 offen sc1
  s_mov_b64 exec, -1
  s_lshl_b32 s56, s56, 3
  s_sub_u32 s56, s56, 12
  v_mov_b32 v27, s56
  s_waitcnt vmcnt(0)
  v_xor_b32 v26, s66, v26
  v_cmp_gt_u32 vcc, 0x10000, v26
  s_nop 1
  v_cndmask_b32 v26, v27, v26, vcc
  v_max_u32 v26, v26, v27
  s_nop 1
  v_add_u32_dpp v26, v26, v26 quad_perm:[1,0,3,2] row_mask:0xf bank_mask:0xf
  s_nop 1
  v_add_u32_dpp v26, v26, v26 quad_perm:[2,3,0,1] row_mask:0xf bank_mask:0xf
  s_nop 1
  v_add_u32_dpp v26, v26, v26 row_half_mirror row_mask:0xf bank_mask:0xf
  s_nop 1
  v_add_u32_dpp v26, v26, v26 row_mirror row_mask:0xf bank_mask:0xf
  v_mov_b32 v27, v26
  s_nop 1
  v_permlane16_swap_b32 v26, v27
  v_add_u32 v26, v26, v27
  v_lshrrev_b32 v26, 1, v26
  s_nop 0
  v_readfirstlane_b32 s56, v26
  s_nop 0
  s_add_u32 s56, s56, 48
  s_lshl_b32 s57, s91, 4
  s_sub_i32 s56, s56, s57
  s_mul_i32 s56, s56, 28
  s_ashr_i32 s56, s56, 8
  s_max_i32 s56, s56, 0
  s_min_i32 s56, s56, 24
  s_add_u32 s92, s92, 0x10000
  s_or_b32 s56, s56, s92
  v_mov_b32 v25, s56
  ds_write_b32 v7, v25 offset:32
L_lagn:
  s_cmp_lt_u32 s91, 496
  s_cbranch_scc1 L_lag
L_nolag:
  s_mov_b32 s58, 8388608
L_polll:
  s_sleep 4
  ds_read_b32 v47, v7
  s_waitcnt lgkmcnt(0)
  v_readfirstlane_b32 s56, v47
  s_nop 0
  s_cmp_ge_u32 s56, 4
  s_cbranch_scc1 L_gotl
  s_sub_u32 s58, s58, 1
  s_cbranch_scc0 L_polll
L_gotl:
  buffer_load_dwordx4 v[64:67], v4, s[40:43], s32 offen offset:0 nt
  buffer_load_dwordx4 v[68:71], v4, s[40:43], s32 offen offset:1152 nt
  buffer_load_dwordx4 v[72:75], v4, s[40:43], s32 offen offset:2304 nt
  buffer_load_dwordx4 v[76:79], v4, s[40:43], s32 offen offset:3456 nt
  buffer_load_dwordx4 v[80:83], v4, s[40:43], s32 offen offset:512 nt
  buffer_load_dwordx4 v[84:87], v4, s[40:43], s32 offen offset:1664 nt
  buffer_load_dwordx4 v[88:91], v4, s[40:43], s32 offen offset:2816 nt
  buffer_load_dwordx4 v[92:95], v4, s[40:43], s32 offen offset:3968 nt
  s_cmp_eq_u32 s3, 3
  s_cbranch_scc0 L_nowd
  s_add_u32 s32, s32, 640
  buffer_load_dwordx4 v[96:99], v4, s[40:43], s32 offen offset:0 nt
  buffer_load_dwordx4 v[100:103], v4, s[40:43], s32 offen offset:1152 nt
  buffer_load_dwordx4 v[104:107], v4, s[40:43], s32 offen offset:2304 nt
  buffer_load_dwordx4 v[108:111], v4, s[40:43], s32 offen offset:3456 nt
L_nowd:
  s_cmp_ge_u32 s53, 9
  s_cselect_b32 s30, 0, s30
  buffer_load_dwordx4 v[128:131], v5, s[28:31], s33 offen nt
  s_add_u32 s33, s33, 9216
  buffer_load_dwordx4 v[132:135], v5, s[28:31], s33 offen nt
  s_add_u32 s33, s33, 9216
  buffer_load_dwordx4 v[136:139], v5, s[28:31], s33 offen nt
  s_add_u32 s33, s33, 9216
  buffer_load_dwordx4 v[140:143], v5, s[28:31], s33 offen nt
  s_add_u32 s33, s33, 9216
  buffer_load_dwordx4 v[144:147], v5, s[28:31], s33 offen nt
  s_add_u32 s33, s33, 9216
  buffer_load_dwordx4 v[148:151], v5, s[28:31], s33 offen nt
  s_add_u32 s33, s33, 9216
  buffer_load_dwordx4 v[152:155], v5, s[28:31], s33 offen nt
  s_add_u32 s33, s33, 9216
  buffer_load_dwordx4 v[156:159], v5, s[28:31], s33 offen nt
  s_lshl_b32 s56, s3, 8
  s_add_u32 s56, s56, s59
  s_add_u32 s56, s56, 4352
  s_waitcnt vmcnt(8)
  v_mfma_f32_16x16x32_bf16 v[188:191], v[36:39], v[64:67], 0
  v_mfma_f32_16x16x32_bf16 v[192:195], v[36:39], v[80:83], 0
  v_mfma_f32_16x16x32_bf16 v[188:191], v[40:43], v[68:71], v[188:191]
  v_mfma_f32_16x16x32_bf16 v[192:195], v[40:43], v[84:87], v[192:195]
  v_mfma_f32_16x16x32_bf16 v[188:191], v[32:35], v[72:75], v[188:191]
  v_mfma_f32_16x16x32_bf16 v[192:195], v[32:35], v[88:91], v[192:195]
  v_mfma_f32_16x16x32_bf16 v[188:191], v[120:123], v[76:79], v[188:191]
  v_mfma_f32_16x16x32_bf16 v[192:195], v[120:123], v[92:95], v[192:195]
  s_nop 6
  v_mov_b32 v200, v188
  v_mov_b32 v201, v189
  v_mov_b32 v202, v190
  v_mov_b32 v203, v191
  v_mov_b32 v204, v192
  v_mov_b32 v205, v193
  v_mov_b32 v206, v194
  v_mov_b32 v207, v195
  v_permlane32_swap_b32 v188, v200
  v_permlane32_swap_b32 v189, v201
  v_permlane32_swap_b32 v190, v202
  v_permlane32_swap_b32 v191, v203
  v_permlane32_swap_b32 v192, v204
  v_permlane32_swap_b32 v193, v205
  v_permlane32_swap_b32 v194, v206
  v_permlane32_swap_b32 v195, v207
  v_add_f32_dpp v188, v200, v188 row_ror:8 row_mask:0xf bank_mask:0xf
  v_add_f32_dpp v189, v201, v189 row_ror:8 row_mask:0xf bank_mask:0xf
  v_add_f32_dpp v190, v202, v190 row_ror:8 row_mask:0xf bank_mask:0xf
  v_add_f32_dpp v191, v203, v191 row_ror:8 row_mask:0xf bank_mask:0xf
  v_add_f32_dpp v192, v204, v192 row_ror:8 row_mask:0xf bank_mask:0xf
  v_add_f32_dpp v193, v205, v193 row_ror:8 row_mask:0xf bank_mask:0xf
  v_add_f32_dpp v194, v206, v194 row_ror:8 row_mask:0xf bank_mask:0xf
  v_add_f32_dpp v195, v207, v195 row_ror:8 row_mask:0xf bank_mask:0xf
  v_cndmask_b32 v188, v188, v192, s[62:63]
  v_cndmask_b32 v189, v189, v193, s[62:63]
  v_cndmask_b32 v190, v190, v194, s[62:63]
  v_cndmask_b32 v191, v191, v195, s[62:63]
  v_bfi_b32 v188, v50, s48, v188
  v_bfi_b32 v189, v50, s49, v189
  v_bfi_b32 v190, v50, s50, v190
  v_bfi_b32 v191, v50, s51, v191
  s_mov_b32 exec_lo, 0x00ff00ff
  s_mov_b32 exec_hi, 0x00ff00ff
  buffer_store_dwordx4 v[188:191], v21, s[44:47], s56 offen sc1
  s_mov_b64 exec, -1
  s_cmp_eq_u32 s3, 3
  s_cbranch_scc0 L_g1done
  v_mfma_f32_16x16x32_bf16 v[196:199], v[36:39], v[96:99], 0
  v_mfma_f32_16x16x32_bf16 v[196:199], v[40:43], v[100:103], v[196:199]
  v_mfma_f32_16x16x32_bf16 v[196:199], v[32:35], v[104:107], v[196:199]
  v_mfma_f32_16x16x32_bf16 v[196:199], v[120:123], v[108:111], v[196:199]
  s_nop 7
  v_mov_b32 v208, v196
  v_mov_b32 v209, v197
  v_mov_b32 v210, v198
  v_mov_b32 v211, v199
  v_permlane32_swap_b32 v196, v208
  v_permlane32_swap_b32 v197, v209
  v_permlane32_swap_b32 v198, v210
  v_permlane32_swap_b32 v199, v211
  v_add_f32_dpp v196, v208, v196 row_ror:8 row_mask:0xf bank_mask:0xf
  v_add_f32_dpp v197, v209, v197 row_ror:8 row_mask:0xf bank_mask:0xf
  v_add_f32_dpp v198, v210, v198 row_ror:8 row_mask:0xf bank_mask:0xf
  v_add_f32_dpp v199, v211, v199 row_ror:8 row_mask:0xf bank_mask:0xf
  v_bfi_b32 v196, v50, s48, v196
  v_bfi_b32 v197, v50, s49, v197
  v_bfi_b32 v198, v50, s50, v198
  v_bfi_b32 v199, v50, s51, v199
  s_mov_b64 exec, 0x00ff00ff
  buffer_store_dwordx4 v[196:199], v3, s[44:47], s56 offen offset:1280 sc1
  s_mov_b64 exec, -1
L_g1done:
  s_cmp_ge_u32 s53, 9
  s_cbranch_scc1 L_spare
  s_mov_b32 s66, 0x0c0c0400
  v_bfe_u32 v14, v0, 3, 1
  v_lshlrev_b32 v14, 4, v14
  s_add_u32 s57, s34, 65536
  s_setprio 3
  s_mov_b32 s58, 8388608
L_polld:
  s_sleep 1
  ds_read_b32 v47, v7 offset:8
  s_waitcnt lgkmcnt(0)
  v_readfirstlane_b32 s56, v47
  s_nop 0
  s_cmp_ge_u32 s56, 5
  s_cbranch_scc1 L_gotd
  s_sub_u32 s58, s58, 1
  s_cbranch_scc0 L_polld
L_gotd:
  s_mov_b64 s[86:87], -1
  s_mov_b64 s[88:89], -1
  s_mov_b32 s58, 2097152
L_pollo:
  s_mov_b64 exec, s[86:87]
  s_cbranch_execz L_pollos0
  buffer_load_dwordx4 v[160:163], v15, s[44:47], s34 offen offset:2816 sc1
  buffer_load_dwordx4 v[164:167], v15, s[44:47], s34 offen offset:2944 sc1
L_pollos0:
  s_mov_b64 exec, s[88:89]
  s_cbranch_execz L_pollos1
  buffer_load_dwordx4 v[168:171], v15, s[44:47], s57 offen offset:2816 sc1
  buffer_load_dwordx4 v[172:175], v15, s[44:47], s57 offen offset:2944 sc1
L_pollos1:
  s_waitcnt vmcnt(0)
  s_mov_b64 exec, s[86:87]
  s_cbranch_execz L_polloc0
  v_xor_b32 v160, s48, v160
  v_xor_b32 v161, s49, v161
  v_xor_b32 v162, s50, v162
  v_xor_b32 v164, s48, v164
  v_xor_b32 v165, s49, v165
  v_xor_b32 v166, s50, v166
  v_or3_b32 v47, v160, v161, v162
  v_or3_b32 v47, v47, v164, v165
  v_or_b32 v47, v47, v166
  v_and_b32 v47, 0xff, v47
  v_cmp_ne_u32 s[86:87], 0, v47
  s_nop 0
  s_or_b32 vcc_lo, s86, s87
  s_lshr_b32 vcc_hi, vcc_lo, 16
  s_or_b32 vcc_lo, vcc_lo, vcc_hi
  s_lshr_b32 vcc_hi, vcc_lo, 8
  s_or_b32 vcc_lo, vcc_lo, vcc_hi
  s_and_b32 vcc_lo, vcc_lo, 0xff
  s_mul_i32 s86, vcc_lo, 0x01010101
  s_mov_b32 s87, s86
L_polloc0:
  s_mov_b64 exec, s[88:89]
  s_cbranch_execz L_polloc1
  v_xor_b32 v168, s48, v168
  v_xor_b32 v169, s49, v169
  v_xor_b32 v170, s50, v170
  v_xor_b32 v172, s48, v172
  v_xor_b32 v173, s49, v173
  v_xor_b32 v174, s50, v174
  v_or3_b32 v48, v168, v169, v170
  v_or3_b32 v48, v48, v172, v173
  v_or_b32 v48, v48, v174
  v_and_b32 v48, 0xff, v48
  v_cmp_ne_u32 s[88:89], 0, v48
  s_nop 0
  s_or_b32 vcc_lo, s88, s89
  s_lshr_b32 vcc_hi, vcc_lo, 16
  s_or_b32 vcc_lo, vcc_lo, vcc_hi
  s_lshr_b32 vcc_hi, vcc_lo, 8
  s_or_b32 vcc_lo, vcc_lo, vcc_hi
  s_and_b32 vcc_lo, vcc_lo, 0xff
  s_mul_i32 s88, vcc_lo, 0x01010101
  s_mov_b32 s89, s88
L_polloc1:
  s_mov_b64 exec, -1
  s_or_b64 vcc, s[86:87], s[88:89]
  s_cbranch_scc0 L_pollod
  s_sub_u32 s58, s58, 1
  s_cbranch_scc0 L_pollo
L_pollod:
  v_perm_b32 v177, v167, v163, s66
  v_perm_b32 v181, v175, v171, s66
  v_lshlrev_b32 v177, v14, v177
  v_lshlrev_b32 v181, v14, v181
  v_and_b32 v163, 0xffffff00, v163
  v_and_b32 v167, 0xffffff00, v167
  v_or_b32_dpp v176, v177, v177 row_ror:8 row_mask:0xf bank_mask:0xf
  v_or_b32_dpp v180, v181, v181 row_ror:8 row_mask:0xf bank_mask:0xf
  v_and_b32 v171, 0xffffff00, v171
  v_and_b32 v175, 0xffffff00, v175
  v_max_f32 v47, v176, v180
  s_nop 1
  v_max_f32_dpp v47, v47, v47 quad_perm:[1,0,3,2] row_mask:0xf bank_mask:0xf
  s_nop 1
  v_max_f32_dpp v47, v47, v47 quad_perm:[2,3,0,1] row_mask:0xf bank_mask:0xf
  s_nop 1
  v_max_f32_dpp v47, v47, v47 row_half_mirror row_mask:0xf bank_mask:0xf
  v_sub_f32 v176, v176, v47
  v_sub_f32 v180, v180, v47
  v_exp_f32 v176, v176
  v_exp_f32 v180, v180
  s_nop 0
  v_add_f32 v177, v176, v180
  v_mul_f32 v160, v176, v160
  v_mul_f32 v161, v176, v161
  v_mul_f32 v162, v176, v162
  v_mul_f32 v163, v176, v163
  v_mul_f32 v164, v176, v164
  v_mul_f32 v165, v176, v165
  v_mul_f32 v166, v176, v166
  v_mul_f32 v167, v176, v167
  v_fmac_f32 v160, v180, v168
  v_fmac_f32 v161, v180, v169
  v_fmac_f32 v162, v180, v170
  v_fmac_f32 v163, v180, v171
  v_fmac_f32 v164, v180, v172
  v_fmac_f32 v165, v180, v173
  v_fmac_f32 v166, v180, v174
  v_fmac_f32 v167, v180, v175
  v_add_f32_dpp v177, v177, v177 quad_perm:[1,0,3,2] row_mask:0xf bank_mask:0xf
  v_add_f32_dpp v160, v160, v160 quad_perm:[1,0,3,2] row_mask:0xf bank_mask:0xf
  v_add_f32_dpp v161, v161, v161 quad_perm:[1,0,3,2] row_mask:0xf bank_mask:0xf
  v_add_f32_dpp v162, v162, v162 quad_perm:[1,0,3,2] row_mask:0xf bank_mask:0xf
  v_add_f32_dpp v163, v163, v163 quad_perm:[1,0,3,2] row_mask:0xf bank_mask:0xf
  v_add_f32_dpp v164, v164, v164 quad_perm:[1,0,3,2] row_mask:0xf bank_mask:0xf
  v_add_f32_dpp v165, v165, v165 quad_perm:[1,0,3,2] row_mask:0xf bank_mask:0xf
  v_add_f32_dpp v166, v166, v166 quad_perm:[1,0,3,2] row_mask:0xf bank_mask:0xf
  v_add_f32_dpp v167, v167, v167 quad_perm:[1,0,3,2] row_mask:0xf bank_mask:0xf
  v_add_f32_dpp v177, v177, v177 quad_perm:[2,3,0,1] row_mask:0xf bank_mask:0xf
  v_add_f32_dpp v160, v160, v160 quad_perm:[2,3,0,1] row_mask:0xf bank_mask:0xf
  v_add_f32_dpp v161, v161, v161 quad_perm:[2,3,0,1] row_mask:0xf bank_mask:0xf
  v_add_f32_dpp v162, v162, v162 quad_perm:[2,3,0,1] row_mask:0xf bank_mask:0xf
  v_add_f32_dpp v163, v163, v163 quad_perm:[2,3,0,1] row_mask:0xf bank_mask:0xf
  v_add_f32_dpp v164, v164, v164 quad_perm:[2,3,0,1] row_mask:0xf bank_mask:0xf
  v_add_f32_dpp v165, v165, v165 quad_perm:[2,3,0,1] row_mask:0xf bank_mask:0xf
  v_add_f32_dpp v166, v166, v166 quad_perm:[2,3,0,1] row_mask:0xf bank_mask:0xf
  v_add_f32_dpp v167, v167, v167 quad_perm:[2,3,0,1] row_mask:0xf bank_mask:0xf
  v_add_f32_dpp v177, v177, v177 row_half_mirror row_mask:0xf bank_mask:0xf
  v_add_f32_dpp v160, v160, v160 row_half_mirror row_mask:0xf bank_mask:0xf
  v_add_f32_dpp v161, v161, v161 row_half_mirror row_mask:0xf bank_mask:0xf
  v_add_f32_dpp v162, v162, v162 row_half_mirror row_mask:0xf bank_mask:0xf
  v_add_f32_dpp v163, v163, v163 row_half_mirror row_mask:0xf bank_mask:0xf
  v_add_f32_dpp v164, v164, v164 row_half_mirror row_mask:0xf bank_mask:0xf
  v_add_f32_dpp v165, v165, v165 row_half_mirror row_mask:0xf bank_mask:0xf
  v_add_f32_dpp v166, v166, v166 row_half_mirror row_mask:0xf bank_mask:0xf
  v_add_f32_dpp v167, v167, v167 row_half_mirror row_mask:0xf bank_mask:0xf
  v_rcp_f32 v177, v177
  s_nop 0
  v_mul_f32 v160, v177, v160
  v_mul_f32 v161, v177, v161
  v_mul_f32 v162, v177, v162
  v_mul_f32 v163, v177, v163
  v_mul_f32 v164, v177, v164
  v_mul_f32 v165, v177, v165
  v_mul_f32 v166, v177, v166
  v_mul_f32 v167, v177, v167
  v_cvt_pk_bf16_f32 v160, v160, v160
  v_cvt_pk_bf16_f32 v161, v161, v161
  v_cvt_pk_bf16_f32 v162, v162, v162
  v_cvt_pk_bf16_f32 v163, v163, v163
  v_cvt_pk_bf16_f32 v164, v164, v164
  v_cvt_pk_bf16_f32 v165, v165, v165
  v_cvt_pk_bf16_f32 v166, v166, v166
  v_cvt_pk_bf16_f32 v167, v167, v167
  v_and_b32 v36, v160, v8
  v_and_b32 v37, v160, v9
  v_and_b32 v38, v160, v10
  v_and_b32 v39, v160, v11
  v_and_b32 v40, v161, v8
  v_and_b32 v41, v161, v9
  v_and_b32 v42, v161, v10
  v_and_b32 v43, v161, v11
  v_mfma_f32_16x16x32_bf16 v[60:63], v[36:39], v[128:131], 0
  v_and_b32 v36, v162, v8
  v_and_b32 v37, v162, v9
  v_and_b32 v38, v162, v10
  v_and_b32 v39, v162, v11
  v_mfma_f32_16x16x32_bf16 v[60:63], v[40:43], v[132:135], v[60:63]
  v_and_b32 v40, v163, v8
  v_and_b32 v41, v163, v9
  v_and_b32 v42, v163, v10
  v_and_b32 v43, v163, v11
  v_mfma_f32_16x16x32_bf16 v[60:63], v[36:39], v[136:139], v[60:63]
  v_and_b32 v36, v164, v8
  v_and_b32 v37, v164, v9
  v_and_b32 v38, v164, v10
  v_and_b32 v39, v164, v11
  v_mfma_f32_16x16x32_bf16 v[60:63], v[40:43], v[140:143], v[60:63]
  v_and_b32 v40, v165, v8
  v_and_b32 v41, v165, v9
  v_and_b32 v42, v165, v10
  v_and_b32 v43, v165, v11
  v_mfma_f32_16x16x32_bf16 v[60:63], v[36:39], v[144:147], v[60:63]
  v_and_b32 v36, v166, v8
  v_and_b32 v37, v166, v9
  v_and_b32 v38, v166, v10
  v_and_b32 v39, v166, v11
  v_mfma_f32_16x16x32_bf16 v[60:63], v[40:43], v[148:151], v[60:63]
  v_and_b32 v40, v167, v8
  v_and_b32 v41, v167, v9
  v_and_b32 v42, v167, v10
  v_and_b32 v43, v167, v11
  v_mfma_f32_16x16x32_bf16 v[60:63], v[36:39], v[152:155], v[60:63]
  s_nop 0
  v_mfma_f32_16x16x32_bf16 v[60:63], v[40:43], v[156:159], v[60:63]
  s_mov_b32 exec_lo, 0x00ff00ff
  s_mov_b32 exec_hi, 0xff00ff00
  s_nop 5
  ds_write_b128 v16, v[60:63]
  s_mov_b64 exec, 1
  ds_add_rtn_u32 v17, v7, v17 offset:12
  s_mov_b64 exec, -1
  ds_read_b128 v[28:31], v18
  ds_read_b128 v[32:35], v18 offset:1024
  s_add_u32 s57, s59, 6656
  s_waitcnt lgkmcnt(2)
  v_readfirstlane_b32 s56, v17
  s_nop 0
  s_cmp_eq_u32 s56, 3
  s_cbranch_scc0 L_end
  s_waitcnt lgkmcnt(0)
  v_add_f32 v28, v28, v32
  v_add_f32 v29, v29, v33
  v_add_f32 v30, v30, v34
  v_add_f32 v31, v31, v35
  v_permlane16_swap_b32 v28, v29
  s_nop 0
  v_permlane16_swap_b32 v30, v31
  v_add_f32 v28, v28, v29
  v_add_f32 v30, v30, v31
  s_nop 1
  v_permlane32_swap_b32 v28, v30
  v_add_f32 v28, v28, v30
  v_mov_b32 v30, v28
  s_nop 1
  v_permlane32_swap_b32 v28, v30
  v_mov_b32 v29, v28
  v_mov_b32 v31, v30
  s_nop 0
  v_permlane16_swap_b32 v28, v29
  v_permlane16_swap_b32 v30, v31
  v_bfi_b32 v28, v50, s48, v28
  v_bfi_b32 v29, v50, s49, v29
  v_bfi_b32 v30, v50, s50, v30
  v_bfi_b32 v31, v50, s51, v31
  s_mov_b64 exec, 0xffff
  buffer_store_dwordx4 v[28:31], v20, s[44:47], s57 offen sc1
  s_mov_b64 exec, -1
  s_cmp_eq_u32 s52, s53
  s_branch L_fin0
L_spare:
  s_cmp_eq_u32 s3, 0
  s_cbranch_scc1 L_t4
  s_sub_u32 s66, s3, 1
  s_mul_i32 s66, s66, 7
  s_add_u32 s66, s66, s53
  s_sub_u32 s66, s66, 9
  s_cmp_ge_u32 s66, 9
  s_cbranch_scc1 L_end
  v_lshrrev_b32 v6, 4, v0
  v_and_b32 v7, 15, v0
  v_lshlrev_b32 v7, 4, v7
  v_lshl_add_u32 v6, v6, 13, v7
  s_lshl_b32 s56, s66, 8
  s_add_u32 s56, s56, s60
  s_add_u32 s32, s56, 4352
  s_add_u32 s33, s32, 32768
  s_add_u32 s34, s32, 65536
  s_add_u32 s35, s32, 98304
  s_lshl_b32 s56, s66, 13
  s_add_u32 s56, s56, s60
  s_add_u32 s56, s56, 6912
  s_mov_b64 s[86:87], -1
  s_mov_b64 s[88:89], -1
  s_mov_b64 s[90:91], -1
  s_mov_b64 s[92:93], -1
  s_mov_b32 s58, 2097152
L_pollg2:
  s_mov_b64 exec, s[86:87]
  s_cbranch_execz L_pollg2s0
  buffer_load_dwordx4 v[64:67], v6, s[44:47], s32 offen sc1
L_pollg2s0:
  s_mov_b64 exec, s[88:89]
  s_cbranch_execz L_pollg2s1
  buffer_load_dwordx4 v[68:71], v6, s[44:47], s33 offen sc1
L_pollg2s1:
  s_mov_b64 exec, s[90:91]
  s_cbranch_execz L_pollg2s2
  buffer_load_dwordx4 v[72:75], v6, s[44:47], s34 offen sc1
L_pollg2s2:
  s_mov_b64 exec, s[92:93]
  s_cbranch_execz L_pollg2s3
  buffer_load_dwordx4 v[76:79], v6, s[44:47], s35 offen sc1
L_pollg2s3:
  s_waitcnt vmcnt(0)
  s_mov_b64 exec, s[86:87]
  s_cbranch_execz L_pollg2c0
  v_xor_b32 v64, s48, v64
  v_xor_b32 v65, s49, v65
  v_xor_b32 v66, s50, v66
  v_xor_b32 v67, s51, v67
  v_or3_b32 v47, v64, v65, v66
  v_or_b32 v47, v47, v67
  v_and_b32 v47, 0xff, v47
  v_cmp_ne_u32 s[86:87], 0, v47
  s_nop 0
  s_lshr_b64 vcc, s[86:87], 4
  s_or_b64 s[86:87], s[86:87], vcc
  s_lshr_b64 vcc, s[86:87], 2
  s_or_b64 s[86:87], s[86:87], vcc
  s_lshr_b64 vcc, s[86:87], 1
  s_or_b64 s[86:87], s[86:87], vcc
  s_and_b32 s86, s86, 0x01010101
  s_and_b32 s87, s87, 0x01010101
  s_mul_i32 s86, s86, 0xff
  s_mul_i32 s87, s87, 0xff
L_pollg2c0:
  s_mov_b64 exec, s[88:89]
  s_cbranch_execz L_pollg2c1
  v_xor_b32 v68, s48, v68
  v_xor_b32 v69, s49, v69
  v_xor_b32 v70, s50, v70
  v_xor_b32 v71, s51, v71
  v_or3_b32 v48, v68, v69, v70
  v_or_b32 v48, v48, v71
  v_and_b32 v48, 0xff, v48
  v_cmp_ne_u32 s[88:89], 0, v48
  s_nop 0
  s_lshr_b64 vcc, s[88:89], 4
  s_or_b64 s[88:89], s[88:89], vcc
  s_lshr_b64 vcc, s[88:89], 2
  s_or_b64 s[88:89], s[88:89], vcc
  s_lshr_b64 vcc, s[88:89], 1
  s_or_b64 s[88:89], s[88:89], vcc
  s_and_b32 s88, s88, 0x01010101
  s_and_b32 s89, s89, 0x01010101
  s_mul_i32 s88, s88, 0xff
  s_mul_i32 s89, s89, 0xff
L_pollg2c1:
  s_mov_b64 exec, s[90:91]
  s_cbranch_execz L_pollg2c2
  v_xor_b32 v72, s48, v72
  v_xor_b32 v73, s49, v73
  v_xor_b32 v74, s50, v74
  v_xor_b32 v75, s51, v75
  v_or3_b32 v49, v72, v73, v74
  v_or_b32 v49, v49, v75
  v_and_b32 v49, 0xff, v49
  v_cmp_ne_u32 s[90:91], 0, v49
  s_nop 0
  s_lshr_b64 vcc, s[90:91], 4
  s_or_b64 s[90:91], s[90:91], vcc
  s_lshr_b64 vcc, s[90:91], 2
  s_or_b64 s[90:91], s[90:91], vcc
  s_lshr_b64 vcc, s[90:91], 1
  s_or_b64 s[90:91], s[90:91], vcc
  s_and_b32 s90, s90, 0x01010101
  s_and_b32 s91, s91, 0x01010101
  s_mul_i32 s90, s90, 0xff
  s_mul_i32 s91, s91, 0xff
L_pollg2c2:
  s_mov_b64 exec, s[92:93]
  s_cbranch_execz L_pollg2c3
  v_xor_b32 v76, s48, v76
  v_xor_b32 v77, s49, v77
  v_xor_b32 v78, s50, v78
  v_xor_b32 v79, s51, v79
  v_or3_b32 v47, v76, v77, v78
  v_or_b32 v47, v47, v79
  v_and_b32 v47, 0xff, v47
  v_cmp_ne_u32 s[92:93], 0, v47
  s_nop 0
  s_lshr_b64 vcc, s[92:93], 4
  s_or_b64 s[92:93], s[92:93], vcc
  s_lshr_b64 vcc, s[92:93], 2
  s_or_b64 s[92:93], s[92:93], vcc
  s_lshr_b64 vcc, s[92:93], 1
  s_or_b64 s[92:93], s[92:93], vcc
  s_and_b32 s92, s92, 0x01010101
  s_and_b32 s93, s93, 0x01010101
  s_mul_i32 s92, s92, 0xff
  s_mul_i32 s93, s93, 0xff
L_pollg2c3:
  s_mov_b64 exec, -1
  s_or_b64 vcc, s[86:87], s[88:89]
  s_or_b64 vcc, vcc, s[90:91]
  s_or_b64 vcc, vcc, s[92:93]
  s_cbranch_scc0 L_pollg2d
  s_sub_u32 s58, s58, 1
  s_cbranch_scc0 L_pollg2
L_pollg2d:
  v_add_f32 v80, v64, v68
  v_add_f32 v81, v65, v69
  v_add_f32 v82, v66, v70
  v_add_f32 v83, v67, v71
  v_add_f32 v84, v72, v76
  v_add_f32 v85, v73, v77
  v_add_f32 v86, v74, v78
  v_add_f32 v87, v75, v79
  v_add_f32 v80, v80, v84
  v_add_f32 v81, v81, v85
  v_add_f32 v82, v82, v86
  v_add_f32 v83, v83, v87
  v_permlane16_swap_b32 v80, v81
  s_nop 0
  v_permlane16_swap_b32 v82, v83
  v_add_f32 v80, v80, v81
  v_add_f32 v82, v82, v83
  s_nop 1
  v_permlane32_swap_b32 v80, v82
  v_add_f32 v80, v80, v82
  v_mov_b32 v82, v80
  s_nop 1
  v_permlane32_swap_b32 v80, v82
  v_mov_b32 v81, v80
  v_mov_b32 v83, v82
  s_nop 0
  v_permlane16_swap_b32 v80, v81
  v_permlane16_swap_b32 v82, v83
  v_bfi_b32 v80, v50, s48, v80
  v_bfi_b32 v81, v50, s49, v81
  v_bfi_b32 v82, v50, s50, v82
  v_bfi_b32 v83, v50, s51, v83
  s_mov_b64 exec, 0xffff
  buffer_store_dwordx4 v[80:83], v7, s[44:47], s56 offen sc1
  s_mov_b64 exec, -1
  s_endpgm
L_t4:
  s_cmp_lt_u32 s53, 14
  s_cbranch_scc1 L_fin0
  s_cmp_ge_u32 s52, 9
  s_cbranch_scc1 L_fin0
  s_sub_u32 s67, 15, s53
  v_and_b32 v6, 7, v0
  v_lshrrev_b32 v7, 4, v0
  v_lshl_add_u32 v7, v6, 2, v7
  v_lshlrev_b32 v7, 1, v7
  s_lshl_b32 s56, s52, 7
  s_lshl_b32 s66, s67, 6
  s_add_u32 s56, s56, s66
  buffer_load_ushort v12, v7, s[36:39], s56 offen
  v_lshlrev_b32 v6, 4, v6
  v_lshrrev_b32 v5, 3, v0
  v_lshl_add_u32 v6, v5, 17, v6
  s_lshl_b32 s32, s52, 13
  s_lshl_b32 s66, s67, 7
  s_add_u32 s32, s32, s66
  s_add_u32 s32, s32, 6656
  s_add_u32 s33, s32, 1048576
  s_mov_b32 s40, s22
  s_mov_b32 s41, s23
  s_mov_b32 s42, 1152
  s_mov_b32 s43, 0x20000
  s_waitcnt vmcnt(0)
  s_mov_b32 s36, s26
  s_mov_b32 s37, s27
  s_mov_b32 s38, 4
  s_mov_b32 s39, 0x20000
  v_lshlrev_b32 v12, 16, v12
  s_mov_b64 s[86:87], -1
  s_mov_b64 s[88:89], -1
  s_mov_b32 s58, 2097152
L_pollz:
  s_mov_b64 exec, s[86:87]
  s_cbranch_execz L_pollzs0
  buffer_load_dwordx4 v[64:67], v6, s[44:47], s32 offen offset:0 sc1
  buffer_load_dwordx4 v[80:83], v6, s[44:47], s32 offen offset:256 sc1
L_pollzs0:
  s_mov_b64 exec, s[88:89]
  s_cbranch_execz L_pollzs1
  buffer_load_dwordx4 v[68:71], v6, s[44:47], s33 offen offset:0 sc1
  buffer_load_dwordx4 v[84:87], v6, s[44:47], s33 offen offset:256 sc1
L_pollzs1:
  s_waitcnt vmcnt(0)
  s_mov_b64 exec, s[86:87]
  s_cbranch_execz L_pollzc0
  v_xor_b32 v64, s48, v64
  v_xor_b32 v65, s49, v65
  v_xor_b32 v66, s50, v66
  v_xor_b32 v67, s51, v67
  v_xor_b32 v80, s48, v80
  v_xor_b32 v81, s49, v81
  v_xor_b32 v82, s50, v82
  v_xor_b32 v83, s51, v83
  v_or3_b32 v47, v64, v65, v66
  v_or3_b32 v47, v47, v67, v80
  v_or3_b32 v47, v47, v81, v82
  v_or_b32 v47, v47, v83
  v_and_b32 v47, 0xff, v47
  v_cmp_ne_u32 s[86:87], 0, v47
  s_nop 0
  s_lshr_b64 vcc, s[86:87], 4
  s_or_b64 s[86:87], s[86:87], vcc
  s_lshr_b64 vcc, s[86:87], 2
  s_or_b64 s[86:87], s[86:87], vcc
  s_lshr_b64 vcc, s[86:87], 1
  s_or_b64 s[86:87], s[86:87], vcc
  s_and_b32 s86, s86, 0x01010101
  s_and_b32 s87, s87, 0x01010101
  s_mul_i32 s86, s86, 0xff
  s_mul_i32 s87, s87, 0xff
L_pollzc0:
  s_mov_b64 exec, s[88:89]
  s_cbranch_execz L_pollzc1
  v_xor_b32 v68, s48, v68
  v_xor_b32 v69, s49, v69
  v_xor_b32 v70, s50, v70
  v_xor_b32 v71, s51, v71
  v_xor_b32 v84, s48, v84
  v_xor_b32 v85, s49, v85
  v_xor_b32 v86, s50, v86
  v_xor_b32 v87, s51, v87
  v_or3_b32 v48, v68, v69, v70
  v_or3_b32 v48, v48, v71, v84
  v_or3_b32 v48, v48, v85, v86
  v_or_b32 v48, v48, v87
  v_and_b32 v48, 0xff, v48
  v_cmp_ne_u32 s[88:89], 0, v48
  s_nop 0
  s_lshr_b64 vcc, s[88:89], 4
  s_or_b64 s[88:89], s[88:89], vcc
  s_lshr_b64 vcc, s[88:89], 2
  s_or_b64 s[88:89], s[88:89], vcc
  s_lshr_b64 vcc, s[88:89], 1
  s_or_b64 s[88:89], s[88:89], vcc
  s_and_b32 s88, s88, 0x01010101
  s_and_b32 s89, s89, 0x01010101
  s_mul_i32 s88, s88, 0xff
  s_mul_i32 s89, s89, 0xff
L_pollzc1:
  s_mov_b64 exec, -1
  s_or_b64 vcc, s[86:87], s[88:89]
  s_cbranch_scc0 L_pollzd
  s_sub_u32 s58, s58, 1
  s_cbranch_scc0 L_pollz
L_pollzd:
  v_add_f32 v64, v64, v68
  v_add_f32 v65, v65, v69
  v_add_f32 v66, v66, v70
  v_add_f32 v67, v67, v71
  v_add_f32 v80, v80, v84
  v_add_f32 v81, v81, v85
  v_add_f32 v82, v82, v86
  v_add_f32 v83, v83, v87
  v_add_f32_dpp v64, v64, v64 row_ror:8 row_mask:0xf bank_mask:0xf
  v_add_f32_dpp v65, v65, v65 row_ror:8 row_mask:0xf bank_mask:0xf
  v_add_f32_dpp v66, v66, v66 row_ror:8 row_mask:0xf bank_mask:0xf
  v_add_f32_dpp v67, v67, v67 row_ror:8 row_mask:0xf bank_mask:0xf
  v_add_f32_dpp v80, v80, v80 row_ror:8 row_mask:0xf bank_mask:0xf
  v_add_f32_dpp v81, v81, v81 row_ror:8 row_mask:0xf bank_mask:0xf
  v_add_f32_dpp v82, v82, v82 row_ror:8 row_mask:0xf bank_mask:0xf
  v_add_f32_dpp v83, v83, v83 row_ror:8 row_mask:0xf bank_mask:0xf
  v_permlane16_swap_b32 v64, v65
  v_permlane16_swap_b32 v66, v67
  v_add_f32 v64, v64, v65
  v_add_f32 v66, v66, v67
  s_nop 1
  v_permlane32_swap_b32 v64, v66
  v_add_f32 v64, v64, v66
  v_permlane16_swap_b32 v80, v81
  v_permlane16_swap_b32 v82, v83
  v_add_f32 v80, v80, v81
  v_add_f32 v82, v82, v83
  s_nop 1
  v_permlane32_swap_b32 v80, v82
  v_add_f32 v80, v80, v82
  v_cvt_pk_bf16_f32 v64, v64, v64
  v_lshlrev_b32 v64, 16, v64
  v_cvt_pk_bf16_f32 v80, v80, v80
  v_lshlrev_b32 v80, 16, v80
  v_add_f32 v12, v12, v64
  v_cvt_pk_bf16_f32 v12, v12, v12
  v_lshlrev_b32 v12, 16, v12
  v_add_f32 v12, v12, v80
  v_cvt_pk_bf16_f32 v12, v12, v12
  s_mov_b32 exec_lo, 0x00ff00ff
  s_mov_b32 exec_hi, 0x00ff00ff
  buffer_store_short v12, v7, s[40:43], s56 offen
  s_cmp_eq_u32 s2, 15
  s_cbranch_scc0 L_fin0
  s_mov_b64 exec, 1
  v_mov_b32 v1, s14
  buffer_store_dword v1, v7, s[36:39], 0 offen sc1
L_fin0:
L_end:
  s_endpgm
.section .rodata,"a"
.p2align 6
.amdhsa_kernel parallel_sum__gqa_block_cached__glu_gated_glu__decode_kernel
  .amdhsa_next_free_vgpr 256
  .amdhsa_next_free_sgpr 98
  .amdhsa_accum_offset 256
  .amdhsa_group_segment_fixed_size 0
  .amdhsa_kernarg_size 96
  .amdhsa_user_sgpr_count 2
  .amdhsa_user_sgpr_kernarg_segment_ptr 1
  .amdhsa_system_sgpr_workgroup_id_x 1
  .amdhsa_float_denorm_mode_32 3
.end_amdhsa_kernel
```
